```python
import torch

def _softmax(x, axis=-1):
    return torch.softmax(x, dim=axis)
def _gelu(x):
    return torch.nn.functional.gelu(x, approximate="tanh")
def _silu(x):
    return torch.nn.functional.silu(x)
def _sigmoid(x):
    return torch.sigmoid(x)
def _layernorm(x, axis=-1, eps=1e-5):
    m = x.mean(dim=axis, keepdim=True)
    v = x.var(dim=axis, keepdim=True, unbiased=False)
    return (x - m) / torch.sqrt(v + eps)
def _scatter_add(tgt, idx, src, axis=0):
    return tgt.clone().index_add_(axis, idx, src)
def _segment_sum(src, seg, n):
    out = torch.zeros((n,) + src.shape[1:], dtype=src.dtype)
    return out.index_add_(0, seg, src)
def _pad(x, pw):
    flat = tuple(v for pair in reversed(pw) for v in pair)
    return torch.nn.functional.pad(x, flat)

kernel_name = 'standalone__gqa_block_cached__near_ridge'

def setup_inputs():

    _w = (lambda a: (lambda t: t.to(torch.bfloat16) if t.is_floating_point() else t)(torch.as_tensor(a)))
    B, Sq, D = 8, 112, 576
    Hq, Hkv, Sk, Dh = 32, 16, 1024, 128
    assert Hq % Hkv == 0, (Hq, Hkv)
    return {
        "x": _w((lambda *s: torch.randn(*s, dtype=torch.bfloat16) * 0.8)(B, Sq, D)),
        "k_cache": _w((lambda *s: torch.randn(*s, dtype=torch.bfloat16) * 0.8)(B, Hkv, Sk, Dh)),
        "v_cache": _w((lambda *s: torch.randn(*s, dtype=torch.bfloat16) * 0.05)(B, Hkv, Sk, Dh)),
        "wq": _w((lambda *s: torch.randn(*s, dtype=torch.bfloat16) * 0.8)(D, Hq * Dh) * (D ** -0.5)),
        "wo": _w((lambda *s: torch.randn(*s, dtype=torch.bfloat16) * 0.05)(Hq * Dh, D) * ((Hq * Dh) ** -0.5)),
    }

def reference(x, k_cache, v_cache, wq, wo):
    B, Sq, D = x.shape
    Hq, Dh = 32, 128
    Hkv = k_cache.shape[1]
    rep = Hq // Hkv
    q = (lambda x, *d: x.permute(*d))((x @ wq).reshape(B, Sq, Hq, Dh), 0, 2, 1, 3)
    k = (lambda x, n, axis: torch.repeat_interleave(x, n, dim=axis))(k_cache, rep, axis=1)
    v = (lambda x, n, axis: torch.repeat_interleave(x, n, dim=axis))(v_cache, rep, axis=1)
    scores = torch.einsum("bhqd,bhkd->bhqk", q, k) * (Dh ** -0.5)
    p = _softmax(scores, axis=-1)
    o = torch.einsum("bhqk,bhkd->bhqd", p, v)
    return (lambda x, *d: x.permute(*d))(o, 0, 2, 1, 3).reshape(B, Sq, Hq * Dh) @ wo
```

```asm
; @launch grid=(256,1,1) block=(256,1,1) lds=163840
.amdgcn_target "amdgcn-amd-amdhsa--gfx950"
.text
.globl standalone__gqa_block_cached__near_ridge_kernel
.p2align 8
.type standalone__gqa_block_cached__near_ridge_kernel,@function
standalone__gqa_block_cached__near_ridge_kernel:
s_cmp_ge_u32 s2, 256
s_cbranch_scc1 L_attn_end
s_load_dwordx16 s[4:19], s[0:1], 0
v_and_b32 v221, 63, v0
v_lshrrev_b32 v1, 6, v0
v_lshrrev_b32 v222, 4, v221
v_readfirstlane_b32 s44, v1
v_and_b32 v223, 15, v221
s_getpc_b64 s[72:73]
L_pc_ref:
s_lshr_b32 s47, s2, 3
s_lshl_b32 s47, s47, 4
s_lshl_b32 s48, s44, 2
s_add_u32 s47, s47, s48
v_and_b32 v28, 3, v221
v_add_u32 v28, s47, v28
v_min_u32 v28, 280, v28
v_lshlrev_b32 v28, 7, v28
v_mov_b32 v29, s73
v_add_co_u32 v28, vcc, s72, v28
s_nop 1
v_addc_co_u32 v29, vcc, 0, v29, vcc
global_load_dword v251, v[28:29], off
s_mov_b32 s60, 0
L_restart:
s_and_b32 s47, s2, 7
s_lshr_b32 s48, s2, 3
s_and_b32 s49, s48, 3
s_lshr_b32 s45, s48, 2
s_lshl_b32 s46, s47, 2
s_add_u32 s46, s46, s49
s_lshl_b32 s47, s49, 1
s_add_u32 s53, s45, s47
s_cmp_ge_u32 s53, 9
s_cselect_b32 s47, 9, 0
s_sub_u32 s53, s53, s47
s_and_b32 s57, s49, 1
s_lshl_b32 s57, s57, 15
s_mov_b32 s57, 0
s_mul_i32 s51, s44, 40960
s_lshr_b32 s47, s44, 1
s_mul_i32 s52, s47, 40960
s_and_b32 s47, s44, 1
s_lshl_b32 s47, s47, 12
s_add_u32 s52, s52, s47
s_lshl_b32 s56, s44, 13
v_lshrrev_b32 v1, 3, v221
v_and_b32 v2, 7, v221
v_lshrrev_b32 v3, 2, v223
v_xor_b32 v3, v3, v222
v_lshlrev_b32 v3, 6, v3
v_and_b32 v4, 3, v223
v_lshlrev_b32 v4, 4, v4
v_add_u32 v3, v3, v4
v_lshlrev_b32 v4, 13, v222
v_add_u32 v3, v3, v4
s_lshl_b32 s47, s44, 17
v_add_u32 v232, s47, v3
v_add_u32 v233, 31744, v232
v_add_u32 v234, 63488, v232
v_add_u32 v235, 95232, v232
v_xor_b32 v3, v2, v222
v_lshlrev_b32 v3, 4, v3
v_mul_u32_u24 v4, 1152, v1
s_mul_i32 s47, s44, 36864
v_add_u32 v4, s47, v4
v_xor_b32 v5, 64, v3
v_add_u32 v236, v4, v3
v_add_u32 v5, v4, v5
v_add_u32 v237, 8192, v5
v_add_u32 v238, 16384, v236
v_add_u32 v239, 24576, v5
s_waitcnt lgkmcnt(0)
s_mul_i32 s47, s45, 129024
s_add_u32 s20, s4, s47
s_addc_u32 s21, s5, 0
s_and_b32 s21, s21, 0xffff
s_mov_b32 s22, 129024
s_mov_b32 s23, 0x20000
s_lshl_b32 s47, s46, 8
s_sub_u32 s48, 4718592, s47
s_add_u32 s24, s10, s47
s_addc_u32 s25, s11, 0
s_and_b32 s25, s25, 0xffff
s_mov_b32 s26, s48
s_mov_b32 s27, 0x20000
s_lshl_b32 s54, s53, 19
s_add_u32 m0, s52, 0
s_lshl_b32 s55, s53, 7
buffer_load_dwordx4 v232, s[24:27], s54 offen  lds
buffer_load_dwordx4 v233, s[24:27], s54 offen offset:1024  lds
buffer_load_dwordx4 v234, s[24:27], s54 offen offset:2048  lds
buffer_load_dwordx4 v235, s[24:27], s54 offen offset:3072  lds
s_add_u32 m0, s52, 81920
s_nop 0
buffer_load_dwordx4 v236, s[20:23], s55 offen  lds
buffer_load_dwordx4 v237, s[20:23], s55 offen offset:1024  lds
buffer_load_dwordx4 v238, s[20:23], s55 offen offset:2048  lds
buffer_load_dwordx4 v239, s[20:23], s55 offen offset:3072  lds
s_lshr_b32 s47, s46, 1
s_lshl_b32 s48, s45, 4
s_add_u32 s47, s47, s48
s_lshl_b32 s47, s47, 18
s_add_u32 s28, s6, s47
s_addc_u32 s29, s7, 0
s_and_b32 s29, s29, 0xffff
s_mov_b32 s30, 262144
s_mov_b32 s31, 0x20000
s_add_u32 s32, s8, s47
s_addc_u32 s33, s9, 0
s_and_b32 s33, s33, 0xffff
s_mov_b32 s34, 262144
s_mov_b32 s35, 0x20000
s_mov_b32 s59, 0x3e0293ee
s_mov_b32 s61, 0x53800000
v_lshlrev_b32 v3, 8, v222
v_xor_b32 v4, v223, v222
v_lshlrev_b32 v4, 4, v4
v_xor_b32 v5, 0, v4
v_add_u32 v208, v3, v5
v_xor_b32 v5, 64, v4
v_add_u32 v209, v3, v5
v_xor_b32 v5, 128, v4
v_add_u32 v210, v3, v5
v_xor_b32 v5, 192, v4
v_add_u32 v211, v3, v5
v_lshrrev_b32 v4, 1, v223
v_xor_b32 v4, v4, v222
v_lshlrev_b32 v4, 5, v4
v_and_b32 v5, 1, v223
v_lshlrev_b32 v5, 4, v5
v_add_u32 v4, v4, v5
v_add_u32 v212, v3, v4
v_xor_b32 v213, 128, v212
v_xor_b32 v3, v222, v223
v_lshlrev_b32 v3, 4, v3
v_lshlrev_b32 v4, 8, v223
v_add_u32 v3, v3, v4
v_add_u32 v3, s51, v3
v_xor_b32 v196, 0, v3
v_xor_b32 v197, 64, v3
v_xor_b32 v198, 128, v3
v_xor_b32 v199, 192, v3
v_lshrrev_b32 v3, 2, v223
v_lshlrev_b32 v4, 2, v222
v_add_u32 v4, v4, v3
v_and_b32 v5, 7, v4
v_lshlrev_b32 v4, 8, v4
v_and_b32 v6, 3, v223
v_lshlrev_b32 v6, 3, v6
v_add_u32 v4, v4, v6
v_add_u32 v4, 16384, v4
v_add_u32 v4, s51, v4
v_lshlrev_b32 v5, 5, v5
s_lshl_b32 s47, s44, 1
s_add_u32 s47, s47, 0
s_and_b32 s47, s47, 7
s_lshl_b32 s47, s47, 5
v_xor_b32 v6, s47, v5
v_add_u32 v200, v4, v6
s_lshl_b32 s47, s44, 1
s_add_u32 s47, s47, 1
s_and_b32 s47, s47, 7
s_lshl_b32 s47, s47, 5
v_xor_b32 v6, s47, v5
v_add_u32 v201, v4, v6
s_lshl_b32 s47, s44, 1
s_add_u32 s47, s47, 2
s_and_b32 s47, s47, 7
s_lshl_b32 s47, s47, 5
v_xor_b32 v6, s47, v5
v_add_u32 v202, v4, v6
s_lshl_b32 s47, s44, 1
s_add_u32 s47, s47, 3
s_and_b32 s47, s47, 7
s_lshl_b32 s47, s47, 5
v_xor_b32 v6, s47, v5
v_add_u32 v203, v4, v6
s_lshl_b32 s47, s44, 1
s_add_u32 s47, s47, 4
s_and_b32 s47, s47, 7
s_lshl_b32 s47, s47, 5
v_xor_b32 v6, s47, v5
v_add_u32 v204, v4, v6
s_lshl_b32 s47, s44, 1
s_add_u32 s47, s47, 5
s_and_b32 s47, s47, 7
s_lshl_b32 s47, s47, 5
v_xor_b32 v6, s47, v5
v_add_u32 v205, v4, v6
s_lshl_b32 s47, s44, 1
s_add_u32 s47, s47, 6
s_and_b32 s47, s47, 7
s_lshl_b32 s47, s47, 5
v_xor_b32 v6, s47, v5
v_add_u32 v206, v4, v6
s_lshl_b32 s47, s44, 1
s_add_u32 s47, s47, 7
s_and_b32 s47, s47, 7
s_lshl_b32 s47, s47, 5
v_xor_b32 v6, s47, v5
v_add_u32 v207, v4, v6
v_lshrrev_b32 v3, 1, v223
v_xor_b32 v3, v3, v222
v_lshlrev_b32 v3, 4, v3
v_lshlrev_b32 v4, 7, v223
v_add_u32 v3, v3, v4
v_add_u32 v72, 81920, v3
v_xor_b32 v3, 64, v3
v_add_u32 v73, 81920, v3
v_add_u32 v74, 40960, v72
v_add_u32 v75, 40960, v73
v_lshrrev_b32 v3, 2, v223
v_lshlrev_b32 v4, 3, v222
v_add_u32 v4, v4, v3
v_lshlrev_b32 v4, 8, v4
v_xor_b32 v3, s44, v3
v_lshlrev_b32 v3, 6, v3
v_add_u32 v4, v4, v3
v_and_b32 v3, 3, v223
v_lshlrev_b32 v3, 4, v3
v_add_u32 v76, v4, v3
v_add_u32 v77, 40960, v76
v_accvgpr_write_b32 a0, 0
v_accvgpr_write_b32 a1, 0
v_accvgpr_write_b32 a2, 0
v_accvgpr_write_b32 a3, 0
v_accvgpr_write_b32 a4, 0
v_accvgpr_write_b32 a5, 0
v_accvgpr_write_b32 a6, 0
v_accvgpr_write_b32 a7, 0
v_accvgpr_write_b32 a8, 0
v_accvgpr_write_b32 a9, 0
v_accvgpr_write_b32 a10, 0
v_accvgpr_write_b32 a11, 0
v_accvgpr_write_b32 a12, 0
v_accvgpr_write_b32 a13, 0
v_accvgpr_write_b32 a14, 0
v_accvgpr_write_b32 a15, 0
v_accvgpr_write_b32 a16, 0
v_accvgpr_write_b32 a17, 0
v_accvgpr_write_b32 a18, 0
v_accvgpr_write_b32 a19, 0
v_accvgpr_write_b32 a20, 0
v_accvgpr_write_b32 a21, 0
v_accvgpr_write_b32 a22, 0
v_accvgpr_write_b32 a23, 0
v_accvgpr_write_b32 a24, 0
v_accvgpr_write_b32 a25, 0
v_accvgpr_write_b32 a26, 0
v_accvgpr_write_b32 a27, 0
v_accvgpr_write_b32 a28, 0
v_accvgpr_write_b32 a29, 0
v_accvgpr_write_b32 a30, 0
v_accvgpr_write_b32 a31, 0
v_accvgpr_write_b32 a32, 0
v_accvgpr_write_b32 a33, 0
v_accvgpr_write_b32 a34, 0
v_accvgpr_write_b32 a35, 0
v_accvgpr_write_b32 a36, 0
v_accvgpr_write_b32 a37, 0
v_accvgpr_write_b32 a38, 0
v_accvgpr_write_b32 a39, 0
v_accvgpr_write_b32 a40, 0
v_accvgpr_write_b32 a41, 0
v_accvgpr_write_b32 a42, 0
v_accvgpr_write_b32 a43, 0
v_accvgpr_write_b32 a44, 0
v_accvgpr_write_b32 a45, 0
v_accvgpr_write_b32 a46, 0
v_accvgpr_write_b32 a47, 0
v_accvgpr_write_b32 a48, 0
v_accvgpr_write_b32 a49, 0
v_accvgpr_write_b32 a50, 0
v_accvgpr_write_b32 a51, 0
v_accvgpr_write_b32 a52, 0
v_accvgpr_write_b32 a53, 0
v_accvgpr_write_b32 a54, 0
v_accvgpr_write_b32 a55, 0
s_lshr_b32 s47, s2, 3
s_lshl_b32 s47, s47, 2
s_add_u32 s47, s47, s44
s_mul_i32 s47, s47, 192
s_add_u32 s47, s47, 0
v_add_u32 v30, s47, v221
v_and_b32 v243, 4095, v30
v_mul_u32_u24 v243, 1152, v243
v_lshrrev_b32 v30, 12, v30
s_and_b32 s48, s2, 1
s_mul_i32 s48, s48, 5
v_add_u32 v31, s48, v30
v_cmp_gt_u32 vcc, 4, v30
v_min_u32 v30, 5, v30
s_nop 0
v_cndmask_b32 v31, 4, v31, vcc
v_lshlrev_b32 v31, 7, v31
v_add_u32 v243, v243, v31
v_cmp_gt_u32 vcc, 5, v30
v_mov_b32 v31, 0x7f000000
s_nop 0
v_cndmask_b32 v243, v31, v243, vcc
s_lshr_b32 s47, s2, 3
s_lshl_b32 s47, s47, 2
s_add_u32 s47, s47, s44
s_mul_i32 s47, s47, 192
s_add_u32 s47, s47, 64
v_add_u32 v30, s47, v221
v_and_b32 v254, 4095, v30
v_mul_u32_u24 v254, 1152, v254
v_lshrrev_b32 v30, 12, v30
s_and_b32 s48, s2, 1
s_mul_i32 s48, s48, 5
v_add_u32 v31, s48, v30
v_cmp_gt_u32 vcc, 4, v30
v_min_u32 v30, 5, v30
s_nop 0
v_cndmask_b32 v31, 4, v31, vcc
v_lshlrev_b32 v31, 7, v31
v_add_u32 v254, v254, v31
v_cmp_gt_u32 vcc, 5, v30
v_mov_b32 v31, 0x7f000000
s_nop 0
v_cndmask_b32 v254, v31, v254, vcc
s_lshr_b32 s47, s2, 3
s_lshl_b32 s47, s47, 2
s_add_u32 s47, s47, s44
s_mul_i32 s47, s47, 192
s_add_u32 s47, s47, 128
v_add_u32 v30, s47, v221
v_and_b32 v255, 4095, v30
v_mul_u32_u24 v255, 1152, v255
v_lshrrev_b32 v30, 12, v30
s_and_b32 s48, s2, 1
s_mul_i32 s48, s48, 5
v_add_u32 v31, s48, v30
v_cmp_gt_u32 vcc, 4, v30
v_min_u32 v30, 5, v30
s_nop 0
v_cndmask_b32 v31, 4, v31, vcc
v_lshlrev_b32 v31, 7, v31
v_add_u32 v255, v255, v31
v_cmp_gt_u32 vcc, 5, v30
v_mov_b32 v31, 0x7f000000
s_nop 0
v_cndmask_b32 v255, v31, v255, vcc
s_add_u32 s53, s53, 1
s_cmp_eq_u32 s53, 9
s_cselect_b32 s53, 0, s53
s_lshl_b32 s54, s53, 19
s_add_u32 m0, s52, 16384
s_lshl_b32 s55, s53, 7
buffer_load_dwordx4 v232, s[24:27], s54 offen  lds
buffer_load_dwordx4 v233, s[24:27], s54 offen offset:1024  lds
buffer_load_dwordx4 v234, s[24:27], s54 offen offset:2048  lds
buffer_load_dwordx4 v235, s[24:27], s54 offen offset:3072  lds
s_add_u32 m0, s52, 98304
s_nop 0
buffer_load_dwordx4 v236, s[20:23], s55 offen  lds
buffer_load_dwordx4 v237, s[20:23], s55 offen offset:1024  lds
buffer_load_dwordx4 v238, s[20:23], s55 offen offset:2048  lds
buffer_load_dwordx4 v239, s[20:23], s55 offen offset:3072  lds
s_waitcnt vmcnt(8)
s_barrier
ds_read_b64_tr_b16 v[56:57], v76 offset:0
ds_read_b64_tr_b16 v[58:59], v76 offset:1024
ds_read_b64_tr_b16 v[60:61], v76 offset:8
ds_read_b64_tr_b16 v[62:63], v76 offset:1032
ds_read_b128 v[0:3], v72 offset:0
ds_read_b128 v[4:7], v72 offset:2048
ds_read_b128 v[8:11], v72 offset:4096
ds_read_b128 v[12:15], v72 offset:6144
ds_read_b128 v[16:19], v74 offset:0
ds_read_b128 v[20:23], v74 offset:2048
ds_read_b128 v[24:27], v74 offset:4096
s_waitcnt lgkmcnt(0)
v_mfma_f32_16x16x32_bf16 a[0:3], v[56:59], v[0:3], a[0:3]
ds_read_b64_tr_b16 v[64:65], v77 offset:0
s_add_u32 s53, s53, 1
s_cmp_eq_u32 s53, 9
s_cselect_b32 s53, 0, s53
s_lshl_b32 s54, s53, 19
s_add_u32 m0, s52, 8192
s_lshl_b32 s55, s53, 7
buffer_load_dwordx4 v232, s[24:27], s54 offen  lds
v_mfma_f32_16x16x32_bf16 a[4:7], v[60:63], v[0:3], a[4:7]
ds_read_b64_tr_b16 v[66:67], v77 offset:1024
buffer_load_dwordx4 v233, s[24:27], s54 offen offset:1024  lds
v_mfma_f32_16x16x32_bf16 a[8:11], v[56:59], v[4:7], a[8:11]
ds_read_b64_tr_b16 v[68:69], v77 offset:8
v_mfma_f32_16x16x32_bf16 a[12:15], v[60:63], v[4:7], a[12:15]
ds_read_b64_tr_b16 v[70:71], v77 offset:1032
buffer_load_dwordx4 v234, s[24:27], s54 offen offset:2048  lds
v_mfma_f32_16x16x32_bf16 a[16:19], v[56:59], v[8:11], a[16:19]
ds_read_b128 v[28:31], v73 offset:0
v_mfma_f32_16x16x32_bf16 a[20:23], v[60:63], v[8:11], a[20:23]
ds_read_b128 v[32:35], v73 offset:2048
buffer_load_dwordx4 v235, s[24:27], s54 offen offset:3072  lds
v_mfma_f32_16x16x32_bf16 a[24:27], v[56:59], v[12:15], a[24:27]
ds_read_b128 v[36:39], v73 offset:4096
v_mfma_f32_16x16x32_bf16 a[28:31], v[60:63], v[12:15], a[28:31]
ds_read_b128 v[40:43], v73 offset:6144
s_add_u32 m0, s52, 90112
s_nop 0
buffer_load_dwordx4 v236, s[20:23], s55 offen  lds
v_mfma_f32_16x16x32_bf16 a[32:35], v[56:59], v[16:19], a[32:35]
ds_read_b128 v[44:47], v75 offset:0
buffer_load_dwordx4 v237, s[20:23], s55 offen offset:1024  lds
v_mfma_f32_16x16x32_bf16 a[36:39], v[60:63], v[16:19], a[36:39]
ds_read_b128 v[48:51], v75 offset:2048
v_mfma_f32_16x16x32_bf16 a[40:43], v[56:59], v[20:23], a[40:43]
ds_read_b128 v[52:55], v75 offset:4096
buffer_load_dwordx4 v238, s[20:23], s55 offen offset:2048  lds
v_mfma_f32_16x16x32_bf16 a[44:47], v[60:63], v[20:23], a[44:47]
v_mfma_f32_16x16x32_bf16 a[48:51], v[56:59], v[24:27], a[48:51]
buffer_load_dwordx4 v239, s[20:23], s55 offen offset:3072  lds
v_mfma_f32_16x16x32_bf16 a[52:55], v[60:63], v[24:27], a[52:55]
s_waitcnt vmcnt(8)
s_waitcnt lgkmcnt(0)
s_barrier
v_mfma_f32_16x16x32_bf16 a[0:3], v[64:67], v[28:31], a[0:3]
ds_read_b64_tr_b16 v[56:57], v76 offset:16384
s_add_u32 s53, s53, 1
s_cmp_eq_u32 s53, 9
s_cselect_b32 s53, 0, s53
s_lshl_b32 s54, s53, 19
s_add_u32 m0, s52, 24576
s_lshl_b32 s55, s53, 7
buffer_load_dwordx4 v232, s[24:27], s54 offen  lds
v_mfma_f32_16x16x32_bf16 a[4:7], v[68:71], v[28:31], a[4:7]
ds_read_b64_tr_b16 v[58:59], v76 offset:17408
buffer_load_dwordx4 v233, s[24:27], s54 offen offset:1024  lds
v_mfma_f32_16x16x32_bf16 a[8:11], v[64:67], v[32:35], a[8:11]
ds_read_b64_tr_b16 v[60:61], v76 offset:16392
v_mfma_f32_16x16x32_bf16 a[12:15], v[68:71], v[32:35], a[12:15]
ds_read_b64_tr_b16 v[62:63], v76 offset:17416
buffer_load_dwordx4 v234, s[24:27], s54 offen offset:2048  lds
v_mfma_f32_16x16x32_bf16 a[16:19], v[64:67], v[36:39], a[16:19]
ds_read_b128 v[0:3], v72 offset:16384
v_mfma_f32_16x16x32_bf16 a[20:23], v[68:71], v[36:39], a[20:23]
ds_read_b128 v[4:7], v72 offset:18432
buffer_load_dwordx4 v235, s[24:27], s54 offen offset:3072  lds
v_mfma_f32_16x16x32_bf16 a[24:27], v[64:67], v[40:43], a[24:27]
ds_read_b128 v[8:11], v72 offset:20480
v_mfma_f32_16x16x32_bf16 a[28:31], v[68:71], v[40:43], a[28:31]
ds_read_b128 v[12:15], v72 offset:22528
s_add_u32 m0, s52, 106496
s_nop 0
buffer_load_dwordx4 v236, s[20:23], s55 offen  lds
v_mfma_f32_16x16x32_bf16 a[32:35], v[64:67], v[44:47], a[32:35]
ds_read_b128 v[16:19], v74 offset:16384
buffer_load_dwordx4 v237, s[20:23], s55 offen offset:1024  lds
v_mfma_f32_16x16x32_bf16 a[36:39], v[68:71], v[44:47], a[36:39]
ds_read_b128 v[20:23], v74 offset:18432
v_mfma_f32_16x16x32_bf16 a[40:43], v[64:67], v[48:51], a[40:43]
ds_read_b128 v[24:27], v74 offset:20480
buffer_load_dwordx4 v238, s[20:23], s55 offen offset:2048  lds
v_mfma_f32_16x16x32_bf16 a[44:47], v[68:71], v[48:51], a[44:47]
v_mfma_f32_16x16x32_bf16 a[48:51], v[64:67], v[52:55], a[48:51]
buffer_load_dwordx4 v239, s[20:23], s55 offen offset:3072  lds
v_mfma_f32_16x16x32_bf16 a[52:55], v[68:71], v[52:55], a[52:55]
s_waitcnt lgkmcnt(0)
v_mfma_f32_16x16x32_bf16 a[0:3], v[56:59], v[0:3], a[0:3]
ds_read_b64_tr_b16 v[64:65], v77 offset:16384
s_add_u32 s53, s53, 1
s_cmp_eq_u32 s53, 9
s_cselect_b32 s53, 0, s53
s_lshl_b32 s54, s53, 19
s_add_u32 m0, s52, 32768
s_lshl_b32 s55, s53, 7
buffer_load_dwordx4 v232, s[24:27], s54 offen  lds
v_mfma_f32_16x16x32_bf16 a[4:7], v[60:63], v[0:3], a[4:7]
ds_read_b64_tr_b16 v[66:67], v77 offset:17408
buffer_load_dwordx4 v233, s[24:27], s54 offen offset:1024  lds
v_mfma_f32_16x16x32_bf16 a[8:11], v[56:59], v[4:7], a[8:11]
ds_read_b64_tr_b16 v[68:69], v77 offset:16392
v_mfma_f32_16x16x32_bf16 a[12:15], v[60:63], v[4:7], a[12:15]
ds_read_b64_tr_b16 v[70:71], v77 offset:17416
buffer_load_dwordx4 v234, s[24:27], s54 offen offset:2048  lds
v_mfma_f32_16x16x32_bf16 a[16:19], v[56:59], v[8:11], a[16:19]
ds_read_b128 v[28:31], v73 offset:16384
v_mfma_f32_16x16x32_bf16 a[20:23], v[60:63], v[8:11], a[20:23]
ds_read_b128 v[32:35], v73 offset:18432
buffer_load_dwordx4 v235, s[24:27], s54 offen offset:3072  lds
v_mfma_f32_16x16x32_bf16 a[24:27], v[56:59], v[12:15], a[24:27]
ds_read_b128 v[36:39], v73 offset:20480
v_mfma_f32_16x16x32_bf16 a[28:31], v[60:63], v[12:15], a[28:31]
ds_read_b128 v[40:43], v73 offset:22528
s_add_u32 m0, s52, 114688
s_nop 0
buffer_load_dwordx4 v236, s[20:23], s55 offen  lds
v_mfma_f32_16x16x32_bf16 a[32:35], v[56:59], v[16:19], a[32:35]
ds_read_b128 v[44:47], v75 offset:16384
buffer_load_dwordx4 v237, s[20:23], s55 offen offset:1024  lds
v_mfma_f32_16x16x32_bf16 a[36:39], v[60:63], v[16:19], a[36:39]
ds_read_b128 v[48:51], v75 offset:18432
v_mfma_f32_16x16x32_bf16 a[40:43], v[56:59], v[20:23], a[40:43]
ds_read_b128 v[52:55], v75 offset:20480
buffer_load_dwordx4 v238, s[20:23], s55 offen offset:2048  lds
v_mfma_f32_16x16x32_bf16 a[44:47], v[60:63], v[20:23], a[44:47]
v_mfma_f32_16x16x32_bf16 a[48:51], v[56:59], v[24:27], a[48:51]
buffer_load_dwordx4 v239, s[20:23], s55 offen offset:3072  lds
v_mfma_f32_16x16x32_bf16 a[52:55], v[60:63], v[24:27], a[52:55]
s_waitcnt vmcnt(16)
s_waitcnt lgkmcnt(0)
s_barrier
v_mfma_f32_16x16x32_bf16 a[0:3], v[64:67], v[28:31], a[0:3]
ds_read_b64_tr_b16 v[56:57], v76 offset:8192
s_add_u32 s53, s53, 1
s_cmp_eq_u32 s53, 9
s_cselect_b32 s53, 0, s53
s_lshl_b32 s54, s53, 19
s_add_u32 m0, s52, 0
s_lshl_b32 s55, s53, 7
buffer_load_dwordx4 v232, s[24:27], s54 offen  lds
v_mfma_f32_16x16x32_bf16 a[4:7], v[68:71], v[28:31], a[4:7]
ds_read_b64_tr_b16 v[58:59], v76 offset:9216
v_mfma_f32_16x16x32_bf16 a[8:11], v[64:67], v[32:35], a[8:11]
ds_read_b64_tr_b16 v[60:61], v76 offset:8200
v_mfma_f32_16x16x32_bf16 a[12:15], v[68:71], v[32:35], a[12:15]
ds_read_b64_tr_b16 v[62:63], v76 offset:9224
buffer_load_dwordx4 v233, s[24:27], s54 offen offset:1024  lds
v_mfma_f32_16x16x32_bf16 a[16:19], v[64:67], v[36:39], a[16:19]
ds_read_b128 v[0:3], v72 offset:8192
v_mfma_f32_16x16x32_bf16 a[20:23], v[68:71], v[36:39], a[20:23]
ds_read_b128 v[4:7], v72 offset:10240
v_mfma_f32_16x16x32_bf16 a[24:27], v[64:67], v[40:43], a[24:27]
ds_read_b128 v[8:11], v72 offset:12288
v_mfma_f32_16x16x32_bf16 a[28:31], v[68:71], v[40:43], a[28:31]
ds_read_b128 v[12:15], v72 offset:14336
buffer_load_dwordx4 v234, s[24:27], s54 offen offset:2048  lds
v_mfma_f32_16x16x32_bf16 a[32:35], v[64:67], v[44:47], a[32:35]
ds_read_b128 v[16:19], v74 offset:8192
v_mfma_f32_16x16x32_bf16 a[36:39], v[68:71], v[44:47], a[36:39]
ds_read_b128 v[20:23], v74 offset:10240
v_mfma_f32_16x16x32_bf16 a[40:43], v[64:67], v[48:51], a[40:43]
ds_read_b128 v[24:27], v74 offset:12288
buffer_load_dwordx4 v235, s[24:27], s54 offen offset:3072  lds
v_mfma_f32_16x16x32_bf16 a[44:47], v[68:71], v[48:51], a[44:47]
v_mfma_f32_16x16x32_bf16 a[48:51], v[64:67], v[52:55], a[48:51]
v_mfma_f32_16x16x32_bf16 a[52:55], v[68:71], v[52:55], a[52:55]
s_waitcnt lgkmcnt(0)
v_mfma_f32_16x16x32_bf16 a[0:3], v[56:59], v[0:3], a[0:3]
ds_read_b64_tr_b16 v[64:65], v77 offset:8192
s_add_u32 m0, s52, 81920
s_nop 0
buffer_load_dwordx4 v236, s[20:23], s55 offen  lds
v_mfma_f32_16x16x32_bf16 a[4:7], v[60:63], v[0:3], a[4:7]
ds_read_b64_tr_b16 v[66:67], v77 offset:9216
v_mfma_f32_16x16x32_bf16 a[8:11], v[56:59], v[4:7], a[8:11]
ds_read_b64_tr_b16 v[68:69], v77 offset:8200
v_mfma_f32_16x16x32_bf16 a[12:15], v[60:63], v[4:7], a[12:15]
ds_read_b64_tr_b16 v[70:71], v77 offset:9224
buffer_load_dwordx4 v237, s[20:23], s55 offen offset:1024  lds
v_mfma_f32_16x16x32_bf16 a[16:19], v[56:59], v[8:11], a[16:19]
ds_read_b128 v[28:31], v73 offset:8192
v_mfma_f32_16x16x32_bf16 a[20:23], v[60:63], v[8:11], a[20:23]
ds_read_b128 v[32:35], v73 offset:10240
v_mfma_f32_16x16x32_bf16 a[24:27], v[56:59], v[12:15], a[24:27]
ds_read_b128 v[36:39], v73 offset:12288
v_mfma_f32_16x16x32_bf16 a[28:31], v[60:63], v[12:15], a[28:31]
ds_read_b128 v[40:43], v73 offset:14336
buffer_load_dwordx4 v238, s[20:23], s55 offen offset:2048  lds
v_mfma_f32_16x16x32_bf16 a[32:35], v[56:59], v[16:19], a[32:35]
ds_read_b128 v[44:47], v75 offset:8192
v_mfma_f32_16x16x32_bf16 a[36:39], v[60:63], v[16:19], a[36:39]
ds_read_b128 v[48:51], v75 offset:10240
v_mfma_f32_16x16x32_bf16 a[40:43], v[56:59], v[20:23], a[40:43]
ds_read_b128 v[52:55], v75 offset:12288
buffer_load_dwordx4 v239, s[20:23], s55 offen offset:3072  lds
v_mfma_f32_16x16x32_bf16 a[44:47], v[60:63], v[20:23], a[44:47]
v_mfma_f32_16x16x32_bf16 a[48:51], v[56:59], v[24:27], a[48:51]
v_mfma_f32_16x16x32_bf16 a[52:55], v[60:63], v[24:27], a[52:55]
s_waitcnt vmcnt(16)
s_waitcnt lgkmcnt(0)
s_barrier
v_mfma_f32_16x16x32_bf16 a[0:3], v[64:67], v[28:31], a[0:3]
ds_read_b64_tr_b16 v[56:57], v76 offset:24576
s_add_u32 s53, s53, 1
s_cmp_eq_u32 s53, 9
s_cselect_b32 s53, 0, s53
s_lshl_b32 s54, s53, 19
s_add_u32 m0, s52, 16384
s_lshl_b32 s55, s53, 7
buffer_load_dwordx4 v232, s[24:27], s54 offen  lds
v_mfma_f32_16x16x32_bf16 a[4:7], v[68:71], v[28:31], a[4:7]
ds_read_b64_tr_b16 v[58:59], v76 offset:25600
v_mfma_f32_16x16x32_bf16 a[8:11], v[64:67], v[32:35], a[8:11]
ds_read_b64_tr_b16 v[60:61], v76 offset:24584
v_mfma_f32_16x16x32_bf16 a[12:15], v[68:71], v[32:35], a[12:15]
ds_read_b64_tr_b16 v[62:63], v76 offset:25608
buffer_load_dwordx4 v233, s[24:27], s54 offen offset:1024  lds
v_mfma_f32_16x16x32_bf16 a[16:19], v[64:67], v[36:39], a[16:19]
ds_read_b128 v[0:3], v72 offset:24576
v_mfma_f32_16x16x32_bf16 a[20:23], v[68:71], v[36:39], a[20:23]
ds_read_b128 v[4:7], v72 offset:26624
v_mfma_f32_16x16x32_bf16 a[24:27], v[64:67], v[40:43], a[24:27]
ds_read_b128 v[8:11], v72 offset:28672
v_mfma_f32_16x16x32_bf16 a[28:31], v[68:71], v[40:43], a[28:31]
ds_read_b128 v[12:15], v72 offset:30720
buffer_load_dwordx4 v234, s[24:27], s54 offen offset:2048  lds
v_mfma_f32_16x16x32_bf16 a[32:35], v[64:67], v[44:47], a[32:35]
ds_read_b128 v[16:19], v74 offset:24576
v_mfma_f32_16x16x32_bf16 a[36:39], v[68:71], v[44:47], a[36:39]
ds_read_b128 v[20:23], v74 offset:26624
v_mfma_f32_16x16x32_bf16 a[40:43], v[64:67], v[48:51], a[40:43]
ds_read_b128 v[24:27], v74 offset:28672
buffer_load_dwordx4 v235, s[24:27], s54 offen offset:3072  lds
v_mfma_f32_16x16x32_bf16 a[44:47], v[68:71], v[48:51], a[44:47]
v_mfma_f32_16x16x32_bf16 a[48:51], v[64:67], v[52:55], a[48:51]
v_mfma_f32_16x16x32_bf16 a[52:55], v[68:71], v[52:55], a[52:55]
s_waitcnt lgkmcnt(0)
v_mfma_f32_16x16x32_bf16 a[0:3], v[56:59], v[0:3], a[0:3]
ds_read_b64_tr_b16 v[64:65], v77 offset:24576
s_add_u32 m0, s52, 98304
s_nop 0
buffer_load_dwordx4 v236, s[20:23], s55 offen  lds
v_mfma_f32_16x16x32_bf16 a[4:7], v[60:63], v[0:3], a[4:7]
ds_read_b64_tr_b16 v[66:67], v77 offset:25600
v_mfma_f32_16x16x32_bf16 a[8:11], v[56:59], v[4:7], a[8:11]
ds_read_b64_tr_b16 v[68:69], v77 offset:24584
v_mfma_f32_16x16x32_bf16 a[12:15], v[60:63], v[4:7], a[12:15]
ds_read_b64_tr_b16 v[70:71], v77 offset:25608
buffer_load_dwordx4 v237, s[20:23], s55 offen offset:1024  lds
v_mfma_f32_16x16x32_bf16 a[16:19], v[56:59], v[8:11], a[16:19]
ds_read_b128 v[28:31], v73 offset:24576
v_mfma_f32_16x16x32_bf16 a[20:23], v[60:63], v[8:11], a[20:23]
ds_read_b128 v[32:35], v73 offset:26624
v_mfma_f32_16x16x32_bf16 a[24:27], v[56:59], v[12:15], a[24:27]
ds_read_b128 v[36:39], v73 offset:28672
v_mfma_f32_16x16x32_bf16 a[28:31], v[60:63], v[12:15], a[28:31]
ds_read_b128 v[40:43], v73 offset:30720
buffer_load_dwordx4 v238, s[20:23], s55 offen offset:2048  lds
v_mfma_f32_16x16x32_bf16 a[32:35], v[56:59], v[16:19], a[32:35]
ds_read_b128 v[44:47], v75 offset:24576
v_mfma_f32_16x16x32_bf16 a[36:39], v[60:63], v[16:19], a[36:39]
ds_read_b128 v[48:51], v75 offset:26624
v_mfma_f32_16x16x32_bf16 a[40:43], v[56:59], v[20:23], a[40:43]
ds_read_b128 v[52:55], v75 offset:28672
buffer_load_dwordx4 v239, s[20:23], s55 offen offset:3072  lds
v_mfma_f32_16x16x32_bf16 a[44:47], v[60:63], v[20:23], a[44:47]
v_mfma_f32_16x16x32_bf16 a[48:51], v[56:59], v[24:27], a[48:51]
v_mfma_f32_16x16x32_bf16 a[52:55], v[60:63], v[24:27], a[52:55]
s_waitcnt vmcnt(16)
s_waitcnt lgkmcnt(0)
s_barrier
v_mfma_f32_16x16x32_bf16 a[0:3], v[64:67], v[28:31], a[0:3]
ds_read_b64_tr_b16 v[56:57], v76 offset:32768
s_add_u32 s53, s53, 1
s_cmp_eq_u32 s53, 9
s_cselect_b32 s53, 0, s53
s_lshl_b32 s54, s53, 19
s_add_u32 m0, s52, 8192
s_lshl_b32 s55, s53, 7
buffer_load_dwordx4 v232, s[24:27], s54 offen  lds
v_mfma_f32_16x16x32_bf16 a[4:7], v[68:71], v[28:31], a[4:7]
ds_read_b64_tr_b16 v[58:59], v76 offset:33792
v_mfma_f32_16x16x32_bf16 a[8:11], v[64:67], v[32:35], a[8:11]
ds_read_b64_tr_b16 v[60:61], v76 offset:32776
v_mfma_f32_16x16x32_bf16 a[12:15], v[68:71], v[32:35], a[12:15]
ds_read_b64_tr_b16 v[62:63], v76 offset:33800
buffer_load_dwordx4 v233, s[24:27], s54 offen offset:1024  lds
v_mfma_f32_16x16x32_bf16 a[16:19], v[64:67], v[36:39], a[16:19]
ds_read_b128 v[0:3], v72 offset:32768
v_mfma_f32_16x16x32_bf16 a[20:23], v[68:71], v[36:39], a[20:23]
ds_read_b128 v[4:7], v72 offset:34816
v_mfma_f32_16x16x32_bf16 a[24:27], v[64:67], v[40:43], a[24:27]
ds_read_b128 v[8:11], v72 offset:36864
v_mfma_f32_16x16x32_bf16 a[28:31], v[68:71], v[40:43], a[28:31]
ds_read_b128 v[12:15], v72 offset:38912
buffer_load_dwordx4 v234, s[24:27], s54 offen offset:2048  lds
v_mfma_f32_16x16x32_bf16 a[32:35], v[64:67], v[44:47], a[32:35]
ds_read_b128 v[16:19], v74 offset:32768
v_mfma_f32_16x16x32_bf16 a[36:39], v[68:71], v[44:47], a[36:39]
ds_read_b128 v[20:23], v74 offset:34816
v_mfma_f32_16x16x32_bf16 a[40:43], v[64:67], v[48:51], a[40:43]
ds_read_b128 v[24:27], v74 offset:36864
buffer_load_dwordx4 v235, s[24:27], s54 offen offset:3072  lds
v_mfma_f32_16x16x32_bf16 a[44:47], v[68:71], v[48:51], a[44:47]
v_mfma_f32_16x16x32_bf16 a[48:51], v[64:67], v[52:55], a[48:51]
v_mfma_f32_16x16x32_bf16 a[52:55], v[68:71], v[52:55], a[52:55]
s_waitcnt lgkmcnt(0)
v_mfma_f32_16x16x32_bf16 a[0:3], v[56:59], v[0:3], a[0:3]
ds_read_b64_tr_b16 v[64:65], v77 offset:32768
s_add_u32 m0, s52, 90112
s_nop 0
buffer_load_dwordx4 v236, s[20:23], s55 offen  lds
v_mfma_f32_16x16x32_bf16 a[4:7], v[60:63], v[0:3], a[4:7]
ds_read_b64_tr_b16 v[66:67], v77 offset:33792
v_mfma_f32_16x16x32_bf16 a[8:11], v[56:59], v[4:7], a[8:11]
ds_read_b64_tr_b16 v[68:69], v77 offset:32776
v_mfma_f32_16x16x32_bf16 a[12:15], v[60:63], v[4:7], a[12:15]
ds_read_b64_tr_b16 v[70:71], v77 offset:33800
buffer_load_dwordx4 v237, s[20:23], s55 offen offset:1024  lds
v_mfma_f32_16x16x32_bf16 a[16:19], v[56:59], v[8:11], a[16:19]
ds_read_b128 v[28:31], v73 offset:32768
v_mfma_f32_16x16x32_bf16 a[20:23], v[60:63], v[8:11], a[20:23]
ds_read_b128 v[32:35], v73 offset:34816
v_mfma_f32_16x16x32_bf16 a[24:27], v[56:59], v[12:15], a[24:27]
ds_read_b128 v[36:39], v73 offset:36864
v_mfma_f32_16x16x32_bf16 a[28:31], v[60:63], v[12:15], a[28:31]
ds_read_b128 v[40:43], v73 offset:38912
buffer_load_dwordx4 v238, s[20:23], s55 offen offset:2048  lds
v_mfma_f32_16x16x32_bf16 a[32:35], v[56:59], v[16:19], a[32:35]
ds_read_b128 v[44:47], v75 offset:32768
v_mfma_f32_16x16x32_bf16 a[36:39], v[60:63], v[16:19], a[36:39]
ds_read_b128 v[48:51], v75 offset:34816
v_mfma_f32_16x16x32_bf16 a[40:43], v[56:59], v[20:23], a[40:43]
ds_read_b128 v[52:55], v75 offset:36864
buffer_load_dwordx4 v239, s[20:23], s55 offen offset:3072  lds
v_mfma_f32_16x16x32_bf16 a[44:47], v[60:63], v[20:23], a[44:47]
v_mfma_f32_16x16x32_bf16 a[48:51], v[56:59], v[24:27], a[48:51]
v_mfma_f32_16x16x32_bf16 a[52:55], v[60:63], v[24:27], a[52:55]
s_waitcnt vmcnt(16)
s_waitcnt lgkmcnt(0)
s_barrier
v_mfma_f32_16x16x32_bf16 a[0:3], v[64:67], v[28:31], a[0:3]
ds_read_b64_tr_b16 v[56:57], v76 offset:0
s_add_u32 s53, s53, 1
s_cmp_eq_u32 s53, 9
s_cselect_b32 s53, 0, s53
s_lshl_b32 s54, s53, 19
s_add_u32 m0, s52, 24576
s_lshl_b32 s55, s53, 7
buffer_load_dwordx4 v232, s[24:27], s54 offen  lds
v_mfma_f32_16x16x32_bf16 a[4:7], v[68:71], v[28:31], a[4:7]
ds_read_b64_tr_b16 v[58:59], v76 offset:1024
v_mfma_f32_16x16x32_bf16 a[8:11], v[64:67], v[32:35], a[8:11]
ds_read_b64_tr_b16 v[60:61], v76 offset:8
v_mfma_f32_16x16x32_bf16 a[12:15], v[68:71], v[32:35], a[12:15]
ds_read_b64_tr_b16 v[62:63], v76 offset:1032
buffer_load_dwordx4 v233, s[24:27], s54 offen offset:1024  lds
v_mfma_f32_16x16x32_bf16 a[16:19], v[64:67], v[36:39], a[16:19]
ds_read_b128 v[0:3], v72 offset:0
v_mfma_f32_16x16x32_bf16 a[20:23], v[68:71], v[36:39], a[20:23]
ds_read_b128 v[4:7], v72 offset:2048
v_mfma_f32_16x16x32_bf16 a[24:27], v[64:67], v[40:43], a[24:27]
ds_read_b128 v[8:11], v72 offset:4096
v_mfma_f32_16x16x32_bf16 a[28:31], v[68:71], v[40:43], a[28:31]
ds_read_b128 v[12:15], v72 offset:6144
buffer_load_dwordx4 v234, s[24:27], s54 offen offset:2048  lds
v_mfma_f32_16x16x32_bf16 a[32:35], v[64:67], v[44:47], a[32:35]
ds_read_b128 v[16:19], v74 offset:0
v_mfma_f32_16x16x32_bf16 a[36:39], v[68:71], v[44:47], a[36:39]
ds_read_b128 v[20:23], v74 offset:2048
v_mfma_f32_16x16x32_bf16 a[40:43], v[64:67], v[48:51], a[40:43]
ds_read_b128 v[24:27], v74 offset:4096
buffer_load_dwordx4 v235, s[24:27], s54 offen offset:3072  lds
v_mfma_f32_16x16x32_bf16 a[44:47], v[68:71], v[48:51], a[44:47]
v_mfma_f32_16x16x32_bf16 a[48:51], v[64:67], v[52:55], a[48:51]
v_mfma_f32_16x16x32_bf16 a[52:55], v[68:71], v[52:55], a[52:55]
s_waitcnt lgkmcnt(0)
v_mfma_f32_16x16x32_bf16 a[0:3], v[56:59], v[0:3], a[0:3]
ds_read_b64_tr_b16 v[64:65], v77 offset:0
s_add_u32 m0, s52, 106496
s_nop 0
buffer_load_dwordx4 v236, s[20:23], s55 offen  lds
v_mfma_f32_16x16x32_bf16 a[4:7], v[60:63], v[0:3], a[4:7]
ds_read_b64_tr_b16 v[66:67], v77 offset:1024
v_mfma_f32_16x16x32_bf16 a[8:11], v[56:59], v[4:7], a[8:11]
ds_read_b64_tr_b16 v[68:69], v77 offset:8
v_mfma_f32_16x16x32_bf16 a[12:15], v[60:63], v[4:7], a[12:15]
ds_read_b64_tr_b16 v[70:71], v77 offset:1032
buffer_load_dwordx4 v237, s[20:23], s55 offen offset:1024  lds
v_mfma_f32_16x16x32_bf16 a[16:19], v[56:59], v[8:11], a[16:19]
ds_read_b128 v[28:31], v73 offset:0
v_mfma_f32_16x16x32_bf16 a[20:23], v[60:63], v[8:11], a[20:23]
ds_read_b128 v[32:35], v73 offset:2048
v_mfma_f32_16x16x32_bf16 a[24:27], v[56:59], v[12:15], a[24:27]
ds_read_b128 v[36:39], v73 offset:4096
v_mfma_f32_16x16x32_bf16 a[28:31], v[60:63], v[12:15], a[28:31]
ds_read_b128 v[40:43], v73 offset:6144
buffer_load_dwordx4 v238, s[20:23], s55 offen offset:2048  lds
v_mfma_f32_16x16x32_bf16 a[32:35], v[56:59], v[16:19], a[32:35]
ds_read_b128 v[44:47], v75 offset:0
v_mfma_f32_16x16x32_bf16 a[36:39], v[60:63], v[16:19], a[36:39]
ds_read_b128 v[48:51], v75 offset:2048
v_mfma_f32_16x16x32_bf16 a[40:43], v[56:59], v[20:23], a[40:43]
ds_read_b128 v[52:55], v75 offset:4096
buffer_load_dwordx4 v239, s[20:23], s55 offen offset:3072  lds
v_mfma_f32_16x16x32_bf16 a[44:47], v[60:63], v[20:23], a[44:47]
v_mfma_f32_16x16x32_bf16 a[48:51], v[56:59], v[24:27], a[48:51]
v_mfma_f32_16x16x32_bf16 a[52:55], v[60:63], v[24:27], a[52:55]
s_waitcnt vmcnt(16)
s_waitcnt lgkmcnt(0)
s_barrier
v_mfma_f32_16x16x32_bf16 a[0:3], v[64:67], v[28:31], a[0:3]
ds_read_b64_tr_b16 v[56:57], v76 offset:16384
s_add_u32 m0, s51, 0
s_add_u32 s58, s56, 0
s_add_u32 s58, s58, s57
buffer_load_dwordx4 v208, s[28:31], s58 offen nt lds
v_mfma_f32_16x16x32_bf16 a[4:7], v[68:71], v[28:31], a[4:7]
ds_read_b64_tr_b16 v[58:59], v76 offset:17408
v_mfma_f32_16x16x32_bf16 a[8:11], v[64:67], v[32:35], a[8:11]
ds_read_b64_tr_b16 v[60:61], v76 offset:16392
v_mfma_f32_16x16x32_bf16 a[12:15], v[68:71], v[32:35], a[12:15]
ds_read_b64_tr_b16 v[62:63], v76 offset:17416
buffer_load_dwordx4 v209, s[28:31], s58 offen offset:1024 nt lds
v_mfma_f32_16x16x32_bf16 a[16:19], v[64:67], v[36:39], a[16:19]
ds_read_b128 v[0:3], v72 offset:16384
v_mfma_f32_16x16x32_bf16 a[20:23], v[68:71], v[36:39], a[20:23]
ds_read_b128 v[4:7], v72 offset:18432
v_mfma_f32_16x16x32_bf16 a[24:27], v[64:67], v[40:43], a[24:27]
ds_read_b128 v[8:11], v72 offset:20480
v_mfma_f32_16x16x32_bf16 a[28:31], v[68:71], v[40:43], a[28:31]
ds_read_b128 v[12:15], v72 offset:22528
buffer_load_dwordx4 v210, s[28:31], s58 offen offset:2048 nt lds
v_mfma_f32_16x16x32_bf16 a[32:35], v[64:67], v[44:47], a[32:35]
ds_read_b128 v[16:19], v74 offset:16384
v_mfma_f32_16x16x32_bf16 a[36:39], v[68:71], v[44:47], a[36:39]
ds_read_b128 v[20:23], v74 offset:18432
v_mfma_f32_16x16x32_bf16 a[40:43], v[64:67], v[48:51], a[40:43]
ds_read_b128 v[24:27], v74 offset:20480
buffer_load_dwordx4 v211, s[28:31], s58 offen offset:3072 nt lds
v_mfma_f32_16x16x32_bf16 a[44:47], v[68:71], v[48:51], a[44:47]
v_mfma_f32_16x16x32_bf16 a[48:51], v[64:67], v[52:55], a[48:51]
v_mfma_f32_16x16x32_bf16 a[52:55], v[68:71], v[52:55], a[52:55]
s_waitcnt lgkmcnt(0)
v_mfma_f32_16x16x32_bf16 a[0:3], v[56:59], v[0:3], a[0:3]
ds_read_b64_tr_b16 v[64:65], v77 offset:16384
s_add_u32 m0, s51, 4096
s_add_u32 s58, s58, 4096
buffer_load_dwordx4 v208, s[28:31], s58 offen nt lds
v_mfma_f32_16x16x32_bf16 a[4:7], v[60:63], v[0:3], a[4:7]
ds_read_b64_tr_b16 v[66:67], v77 offset:17408
v_mfma_f32_16x16x32_bf16 a[8:11], v[56:59], v[4:7], a[8:11]
ds_read_b64_tr_b16 v[68:69], v77 offset:16392
v_mfma_f32_16x16x32_bf16 a[12:15], v[60:63], v[4:7], a[12:15]
ds_read_b64_tr_b16 v[70:71], v77 offset:17416
buffer_load_dwordx4 v209, s[28:31], s58 offen offset:1024 nt lds
v_mfma_f32_16x16x32_bf16 a[16:19], v[56:59], v[8:11], a[16:19]
ds_read_b128 v[28:31], v73 offset:16384
v_mfma_f32_16x16x32_bf16 a[20:23], v[60:63], v[8:11], a[20:23]
ds_read_b128 v[32:35], v73 offset:18432
v_mfma_f32_16x16x32_bf16 a[24:27], v[56:59], v[12:15], a[24:27]
ds_read_b128 v[36:39], v73 offset:20480
v_mfma_f32_16x16x32_bf16 a[28:31], v[60:63], v[12:15], a[28:31]
ds_read_b128 v[40:43], v73 offset:22528
buffer_load_dwordx4 v210, s[28:31], s58 offen offset:2048 nt lds
v_mfma_f32_16x16x32_bf16 a[32:35], v[56:59], v[16:19], a[32:35]
ds_read_b128 v[44:47], v75 offset:16384
v_mfma_f32_16x16x32_bf16 a[36:39], v[60:63], v[16:19], a[36:39]
ds_read_b128 v[48:51], v75 offset:18432
v_mfma_f32_16x16x32_bf16 a[40:43], v[56:59], v[20:23], a[40:43]
ds_read_b128 v[52:55], v75 offset:20480
buffer_load_dwordx4 v211, s[28:31], s58 offen offset:3072 nt lds
v_mfma_f32_16x16x32_bf16 a[44:47], v[60:63], v[20:23], a[44:47]
v_mfma_f32_16x16x32_bf16 a[48:51], v[56:59], v[24:27], a[48:51]
v_mfma_f32_16x16x32_bf16 a[52:55], v[60:63], v[24:27], a[52:55]
s_waitcnt vmcnt(16)
s_waitcnt lgkmcnt(0)
s_barrier
v_mfma_f32_16x16x32_bf16 a[0:3], v[64:67], v[28:31], a[0:3]
ds_read_b64_tr_b16 v[56:57], v76 offset:8192
s_add_u32 m0, s51, 16384
s_add_u32 s58, s56, 0
s_add_u32 s58, s58, s57
buffer_load_dwordx4 v212, s[32:35], s58 offen nt lds
v_mfma_f32_16x16x32_bf16 a[4:7], v[68:71], v[28:31], a[4:7]
ds_read_b64_tr_b16 v[58:59], v76 offset:9216
v_mfma_f32_16x16x32_bf16 a[8:11], v[64:67], v[32:35], a[8:11]
ds_read_b64_tr_b16 v[60:61], v76 offset:8200
v_mfma_f32_16x16x32_bf16 a[12:15], v[68:71], v[32:35], a[12:15]
ds_read_b64_tr_b16 v[62:63], v76 offset:9224
buffer_load_dwordx4 v213, s[32:35], s58 offen offset:1024 nt lds
v_mfma_f32_16x16x32_bf16 a[16:19], v[64:67], v[36:39], a[16:19]
ds_read_b128 v[0:3], v72 offset:8192
v_mfma_f32_16x16x32_bf16 a[20:23], v[68:71], v[36:39], a[20:23]
ds_read_b128 v[4:7], v72 offset:10240
v_mfma_f32_16x16x32_bf16 a[24:27], v[64:67], v[40:43], a[24:27]
ds_read_b128 v[8:11], v72 offset:12288
v_mfma_f32_16x16x32_bf16 a[28:31], v[68:71], v[40:43], a[28:31]
ds_read_b128 v[12:15], v72 offset:14336
buffer_load_dwordx4 v212, s[32:35], s58 offen offset:2048 nt lds
v_mfma_f32_16x16x32_bf16 a[32:35], v[64:67], v[44:47], a[32:35]
ds_read_b128 v[16:19], v74 offset:8192
v_mfma_f32_16x16x32_bf16 a[36:39], v[68:71], v[44:47], a[36:39]
ds_read_b128 v[20:23], v74 offset:10240
v_mfma_f32_16x16x32_bf16 a[40:43], v[64:67], v[48:51], a[40:43]
ds_read_b128 v[24:27], v74 offset:12288
buffer_load_dwordx4 v213, s[32:35], s58 offen offset:3072 nt lds
v_mfma_f32_16x16x32_bf16 a[44:47], v[68:71], v[48:51], a[44:47]
v_mfma_f32_16x16x32_bf16 a[48:51], v[64:67], v[52:55], a[48:51]
v_mfma_f32_16x16x32_bf16 a[52:55], v[68:71], v[52:55], a[52:55]
s_waitcnt lgkmcnt(0)
v_mfma_f32_16x16x32_bf16 a[0:3], v[56:59], v[0:3], a[0:3]
ds_read_b64_tr_b16 v[64:65], v77 offset:8192
s_add_u32 m0, s51, 20480
s_add_u32 s58, s58, 4096
buffer_load_dwordx4 v212, s[32:35], s58 offen nt lds
v_mfma_f32_16x16x32_bf16 a[4:7], v[60:63], v[0:3], a[4:7]
ds_read_b64_tr_b16 v[66:67], v77 offset:9216
v_mfma_f32_16x16x32_bf16 a[8:11], v[56:59], v[4:7], a[8:11]
ds_read_b64_tr_b16 v[68:69], v77 offset:8200
v_mfma_f32_16x16x32_bf16 a[12:15], v[60:63], v[4:7], a[12:15]
ds_read_b64_tr_b16 v[70:71], v77 offset:9224
buffer_load_dwordx4 v213, s[32:35], s58 offen offset:1024 nt lds
v_mfma_f32_16x16x32_bf16 a[16:19], v[56:59], v[8:11], a[16:19]
ds_read_b128 v[28:31], v73 offset:8192
v_mfma_f32_16x16x32_bf16 a[20:23], v[60:63], v[8:11], a[20:23]
ds_read_b128 v[32:35], v73 offset:10240
v_mfma_f32_16x16x32_bf16 a[24:27], v[56:59], v[12:15], a[24:27]
ds_read_b128 v[36:39], v73 offset:12288
v_mfma_f32_16x16x32_bf16 a[28:31], v[60:63], v[12:15], a[28:31]
ds_read_b128 v[40:43], v73 offset:14336
buffer_load_dwordx4 v212, s[32:35], s58 offen offset:2048 nt lds
v_mfma_f32_16x16x32_bf16 a[32:35], v[56:59], v[16:19], a[32:35]
ds_read_b128 v[44:47], v75 offset:8192
v_mfma_f32_16x16x32_bf16 a[36:39], v[60:63], v[16:19], a[36:39]
ds_read_b128 v[48:51], v75 offset:10240
v_mfma_f32_16x16x32_bf16 a[40:43], v[56:59], v[20:23], a[40:43]
ds_read_b128 v[52:55], v75 offset:12288
buffer_load_dwordx4 v213, s[32:35], s58 offen offset:3072 nt lds
v_mfma_f32_16x16x32_bf16 a[44:47], v[60:63], v[20:23], a[44:47]
v_mfma_f32_16x16x32_bf16 a[48:51], v[56:59], v[24:27], a[48:51]
v_mfma_f32_16x16x32_bf16 a[52:55], v[60:63], v[24:27], a[52:55]
s_waitcnt vmcnt(16)
s_waitcnt lgkmcnt(0)
s_barrier
v_mfma_f32_16x16x32_bf16 a[0:3], v[64:67], v[28:31], a[0:3]
ds_read_b64_tr_b16 v[56:57], v76 offset:24576
s_add_u32 m0, s51, 8192
s_add_u32 s58, s56, 32768
s_sub_u32 s58, s58, s57
buffer_load_dwordx4 v208, s[28:31], s58 offen nt lds
v_mfma_f32_16x16x32_bf16 a[4:7], v[68:71], v[28:31], a[4:7]
ds_read_b64_tr_b16 v[58:59], v76 offset:25600
v_mfma_f32_16x16x32_bf16 a[8:11], v[64:67], v[32:35], a[8:11]
ds_read_b64_tr_b16 v[60:61], v76 offset:24584
v_mfma_f32_16x16x32_bf16 a[12:15], v[68:71], v[32:35], a[12:15]
ds_read_b64_tr_b16 v[62:63], v76 offset:25608
buffer_load_dwordx4 v209, s[28:31], s58 offen offset:1024 nt lds
v_mfma_f32_16x16x32_bf16 a[16:19], v[64:67], v[36:39], a[16:19]
ds_read_b128 v[0:3], v72 offset:24576
v_mfma_f32_16x16x32_bf16 a[20:23], v[68:71], v[36:39], a[20:23]
ds_read_b128 v[4:7], v72 offset:26624
v_mfma_f32_16x16x32_bf16 a[24:27], v[64:67], v[40:43], a[24:27]
ds_read_b128 v[8:11], v72 offset:28672
v_mfma_f32_16x16x32_bf16 a[28:31], v[68:71], v[40:43], a[28:31]
ds_read_b128 v[12:15], v72 offset:30720
buffer_load_dwordx4 v210, s[28:31], s58 offen offset:2048 nt lds
v_mfma_f32_16x16x32_bf16 a[32:35], v[64:67], v[44:47], a[32:35]
ds_read_b128 v[16:19], v74 offset:24576
v_mfma_f32_16x16x32_bf16 a[36:39], v[68:71], v[44:47], a[36:39]
ds_read_b128 v[20:23], v74 offset:26624
v_mfma_f32_16x16x32_bf16 a[40:43], v[64:67], v[48:51], a[40:43]
ds_read_b128 v[24:27], v74 offset:28672
buffer_load_dwordx4 v211, s[28:31], s58 offen offset:3072 nt lds
v_mfma_f32_16x16x32_bf16 a[44:47], v[68:71], v[48:51], a[44:47]
v_mfma_f32_16x16x32_bf16 a[48:51], v[64:67], v[52:55], a[48:51]
v_mfma_f32_16x16x32_bf16 a[52:55], v[68:71], v[52:55], a[52:55]
s_waitcnt lgkmcnt(0)
v_mfma_f32_16x16x32_bf16 a[0:3], v[56:59], v[0:3], a[0:3]
ds_read_b64_tr_b16 v[64:65], v77 offset:24576
s_add_u32 m0, s51, 12288
s_add_u32 s58, s58, 4096
buffer_load_dwordx4 v208, s[28:31], s58 offen nt lds
v_mfma_f32_16x16x32_bf16 a[4:7], v[60:63], v[0:3], a[4:7]
ds_read_b64_tr_b16 v[66:67], v77 offset:25600
v_mfma_f32_16x16x32_bf16 a[8:11], v[56:59], v[4:7], a[8:11]
ds_read_b64_tr_b16 v[68:69], v77 offset:24584
v_mfma_f32_16x16x32_bf16 a[12:15], v[60:63], v[4:7], a[12:15]
ds_read_b64_tr_b16 v[70:71], v77 offset:25608
buffer_load_dwordx4 v209, s[28:31], s58 offen offset:1024 nt lds
v_mfma_f32_16x16x32_bf16 a[16:19], v[56:59], v[8:11], a[16:19]
ds_read_b128 v[28:31], v73 offset:24576
v_mfma_f32_16x16x32_bf16 a[20:23], v[60:63], v[8:11], a[20:23]
ds_read_b128 v[32:35], v73 offset:26624
v_mfma_f32_16x16x32_bf16 a[24:27], v[56:59], v[12:15], a[24:27]
ds_read_b128 v[36:39], v73 offset:28672
v_mfma_f32_16x16x32_bf16 a[28:31], v[60:63], v[12:15], a[28:31]
ds_read_b128 v[40:43], v73 offset:30720
buffer_load_dwordx4 v210, s[28:31], s58 offen offset:2048 nt lds
v_mfma_f32_16x16x32_bf16 a[32:35], v[56:59], v[16:19], a[32:35]
ds_read_b128 v[44:47], v75 offset:24576
v_mfma_f32_16x16x32_bf16 a[36:39], v[60:63], v[16:19], a[36:39]
ds_read_b128 v[48:51], v75 offset:26624
v_mfma_f32_16x16x32_bf16 a[40:43], v[56:59], v[20:23], a[40:43]
ds_read_b128 v[52:55], v75 offset:28672
buffer_load_dwordx4 v211, s[28:31], s58 offen offset:3072 nt lds
v_mfma_f32_16x16x32_bf16 a[44:47], v[60:63], v[20:23], a[44:47]
v_mfma_f32_16x16x32_bf16 a[48:51], v[56:59], v[24:27], a[48:51]
v_mfma_f32_16x16x32_bf16 a[52:55], v[60:63], v[24:27], a[52:55]
s_waitcnt lgkmcnt(0)
v_mfma_f32_16x16x32_bf16 a[0:3], v[64:67], v[28:31], a[0:3]
v_mfma_f32_16x16x32_bf16 a[4:7], v[68:71], v[28:31], a[4:7]
v_mfma_f32_16x16x32_bf16 a[8:11], v[64:67], v[32:35], a[8:11]
v_mfma_f32_16x16x32_bf16 a[12:15], v[68:71], v[32:35], a[12:15]
v_mfma_f32_16x16x32_bf16 a[16:19], v[64:67], v[36:39], a[16:19]
v_mfma_f32_16x16x32_bf16 a[20:23], v[68:71], v[36:39], a[20:23]
v_mfma_f32_16x16x32_bf16 a[24:27], v[64:67], v[40:43], a[24:27]
v_mfma_f32_16x16x32_bf16 a[28:31], v[68:71], v[40:43], a[28:31]
v_mfma_f32_16x16x32_bf16 a[32:35], v[64:67], v[44:47], a[32:35]
v_mfma_f32_16x16x32_bf16 a[36:39], v[68:71], v[44:47], a[36:39]
v_mfma_f32_16x16x32_bf16 a[40:43], v[64:67], v[48:51], a[40:43]
v_mfma_f32_16x16x32_bf16 a[44:47], v[68:71], v[48:51], a[44:47]
v_mfma_f32_16x16x32_bf16 a[48:51], v[64:67], v[52:55], a[48:51]
v_mfma_f32_16x16x32_bf16 a[52:55], v[68:71], v[52:55], a[52:55]
v_lshlrev_b32 v240, 4, v221
v_add_u32 v241, s51, v240
v_mov_b32 v242, s59
v_add_u32 v244, 32768, v240
v_add_u32 v245, 114688, v240
v_subrev_u32 v248, s51, v196
v_subrev_u32 v249, s51, v197
v_subrev_u32 v250, s51, v198
v_subrev_u32 v251, s51, v199
v_accvgpr_read_b32 v224, a0
v_accvgpr_read_b32 v225, a1
v_accvgpr_read_b32 v226, a2
v_accvgpr_read_b32 v227, a3
v_accvgpr_read_b32 v228, a4
v_accvgpr_read_b32 v229, a5
v_accvgpr_read_b32 v230, a6
v_accvgpr_read_b32 v231, a7
v_pk_mul_f32 v[224:225], v[224:225], v[242:243] op_sel_hi:[1,0]
v_pk_mul_f32 v[226:227], v[226:227], v[242:243] op_sel_hi:[1,0]
v_pk_mul_f32 v[228:229], v[228:229], v[242:243] op_sel_hi:[1,0]
v_pk_mul_f32 v[230:231], v[230:231], v[242:243] op_sel_hi:[1,0]
v_cvt_pk_bf16_f32 v108, v224, v225
v_cvt_pk_bf16_f32 v109, v226, v227
v_cvt_pk_bf16_f32 v110, v228, v229
v_cvt_pk_bf16_f32 v111, v230, v231
ds_write_b128 v241, v[108:111] offset:32768
v_accvgpr_read_b32 v232, a8
v_accvgpr_read_b32 v233, a9
v_accvgpr_read_b32 v234, a10
v_accvgpr_read_b32 v235, a11
v_accvgpr_read_b32 v236, a12
v_accvgpr_read_b32 v237, a13
v_accvgpr_read_b32 v238, a14
v_accvgpr_read_b32 v239, a15
v_pk_mul_f32 v[232:233], v[232:233], v[242:243] op_sel_hi:[1,0]
v_pk_mul_f32 v[234:235], v[234:235], v[242:243] op_sel_hi:[1,0]
v_pk_mul_f32 v[236:237], v[236:237], v[242:243] op_sel_hi:[1,0]
v_pk_mul_f32 v[238:239], v[238:239], v[242:243] op_sel_hi:[1,0]
v_cvt_pk_bf16_f32 v112, v232, v233
v_cvt_pk_bf16_f32 v113, v234, v235
v_cvt_pk_bf16_f32 v114, v236, v237
v_cvt_pk_bf16_f32 v115, v238, v239
ds_write_b128 v241, v[112:115] offset:33792
v_accvgpr_read_b32 v224, a16
v_accvgpr_read_b32 v225, a17
v_accvgpr_read_b32 v226, a18
v_accvgpr_read_b32 v227, a19
v_accvgpr_read_b32 v228, a20
v_accvgpr_read_b32 v229, a21
v_accvgpr_read_b32 v230, a22
v_accvgpr_read_b32 v231, a23
v_pk_mul_f32 v[224:225], v[224:225], v[242:243] op_sel_hi:[1,0]
v_pk_mul_f32 v[226:227], v[226:227], v[242:243] op_sel_hi:[1,0]
v_pk_mul_f32 v[228:229], v[228:229], v[242:243] op_sel_hi:[1,0]
v_pk_mul_f32 v[230:231], v[230:231], v[242:243] op_sel_hi:[1,0]
v_cvt_pk_bf16_f32 v116, v224, v225
v_cvt_pk_bf16_f32 v117, v226, v227
v_cvt_pk_bf16_f32 v118, v228, v229
v_cvt_pk_bf16_f32 v119, v230, v231
ds_write_b128 v241, v[116:119] offset:34816
v_accvgpr_read_b32 v232, a24
v_accvgpr_read_b32 v233, a25
v_accvgpr_read_b32 v234, a26
v_accvgpr_read_b32 v235, a27
v_accvgpr_read_b32 v236, a28
v_accvgpr_read_b32 v237, a29
v_accvgpr_read_b32 v238, a30
v_accvgpr_read_b32 v239, a31
v_pk_mul_f32 v[232:233], v[232:233], v[242:243] op_sel_hi:[1,0]
v_pk_mul_f32 v[234:235], v[234:235], v[242:243] op_sel_hi:[1,0]
v_pk_mul_f32 v[236:237], v[236:237], v[242:243] op_sel_hi:[1,0]
v_pk_mul_f32 v[238:239], v[238:239], v[242:243] op_sel_hi:[1,0]
v_cvt_pk_bf16_f32 v120, v232, v233
v_cvt_pk_bf16_f32 v121, v234, v235
v_cvt_pk_bf16_f32 v122, v236, v237
v_cvt_pk_bf16_f32 v123, v238, v239
ds_write_b128 v241, v[120:123] offset:35840
v_accvgpr_read_b32 v224, a32
v_accvgpr_read_b32 v225, a33
v_accvgpr_read_b32 v226, a34
v_accvgpr_read_b32 v227, a35
v_accvgpr_read_b32 v228, a36
v_accvgpr_read_b32 v229, a37
v_accvgpr_read_b32 v230, a38
v_accvgpr_read_b32 v231, a39
v_pk_mul_f32 v[224:225], v[224:225], v[242:243] op_sel_hi:[1,0]
v_pk_mul_f32 v[226:227], v[226:227], v[242:243] op_sel_hi:[1,0]
v_pk_mul_f32 v[228:229], v[228:229], v[242:243] op_sel_hi:[1,0]
v_pk_mul_f32 v[230:231], v[230:231], v[242:243] op_sel_hi:[1,0]
v_cvt_pk_bf16_f32 v124, v224, v225
v_cvt_pk_bf16_f32 v125, v226, v227
v_cvt_pk_bf16_f32 v126, v228, v229
v_cvt_pk_bf16_f32 v127, v230, v231
ds_write_b128 v241, v[124:127] offset:36864
v_accvgpr_read_b32 v232, a40
v_accvgpr_read_b32 v233, a41
v_accvgpr_read_b32 v234, a42
v_accvgpr_read_b32 v235, a43
v_accvgpr_read_b32 v236, a44
v_accvgpr_read_b32 v237, a45
v_accvgpr_read_b32 v238, a46
v_accvgpr_read_b32 v239, a47
v_pk_mul_f32 v[232:233], v[232:233], v[242:243] op_sel_hi:[1,0]
v_pk_mul_f32 v[234:235], v[234:235], v[242:243] op_sel_hi:[1,0]
v_pk_mul_f32 v[236:237], v[236:237], v[242:243] op_sel_hi:[1,0]
v_pk_mul_f32 v[238:239], v[238:239], v[242:243] op_sel_hi:[1,0]
v_cvt_pk_bf16_f32 v128, v232, v233
v_cvt_pk_bf16_f32 v129, v234, v235
v_cvt_pk_bf16_f32 v130, v236, v237
v_cvt_pk_bf16_f32 v131, v238, v239
ds_write_b128 v241, v[128:131] offset:37888
v_accvgpr_read_b32 v224, a48
v_accvgpr_read_b32 v225, a49
v_accvgpr_read_b32 v226, a50
v_accvgpr_read_b32 v227, a51
v_accvgpr_read_b32 v228, a52
v_accvgpr_read_b32 v229, a53
v_accvgpr_read_b32 v230, a54
v_accvgpr_read_b32 v231, a55
v_pk_mul_f32 v[224:225], v[224:225], v[242:243] op_sel_hi:[1,0]
v_pk_mul_f32 v[226:227], v[226:227], v[242:243] op_sel_hi:[1,0]
v_pk_mul_f32 v[228:229], v[228:229], v[242:243] op_sel_hi:[1,0]
v_pk_mul_f32 v[230:231], v[230:231], v[242:243] op_sel_hi:[1,0]
v_cvt_pk_bf16_f32 v132, v224, v225
v_cvt_pk_bf16_f32 v133, v226, v227
v_cvt_pk_bf16_f32 v134, v228, v229
v_cvt_pk_bf16_f32 v135, v230, v231
ds_write_b128 v241, v[132:135] offset:38912
s_waitcnt vmcnt(16)
s_waitcnt lgkmcnt(0)
s_barrier
s_cmp_lg_u32 s60, 0
s_cbranch_scc1 L_qread_tm
ds_read_b128 v[140:143], v248 offset:0
ds_read_b128 v[144:147], v249 offset:0
ds_read_b128 v[148:151], v250 offset:0
ds_read_b128 v[152:155], v251 offset:0
ds_read_b128 v[0:3], v244 offset:0
ds_read_b128 v[4:7], v244 offset:40960
ds_read_b128 v[8:11], v245 offset:0
ds_read_b128 v[12:15], v245 offset:40960
ds_read_b128 v[16:19], v244 offset:1024
ds_read_b128 v[20:23], v244 offset:41984
ds_read_b128 v[24:27], v245 offset:1024
ds_read_b128 v[28:31], v245 offset:41984
ds_read_b128 v[32:35], v244 offset:2048
ds_read_b128 v[36:39], v244 offset:43008
ds_read_b128 v[40:43], v245 offset:2048
ds_read_b128 v[44:47], v245 offset:43008
ds_read_b128 v[48:51], v244 offset:3072
ds_read_b128 v[52:55], v244 offset:44032
ds_read_b128 v[56:59], v245 offset:3072
ds_read_b128 v[60:63], v245 offset:44032
ds_read_b128 v[64:67], v244 offset:4096
ds_read_b128 v[68:71], v244 offset:45056
ds_read_b128 v[72:75], v245 offset:4096
ds_read_b128 v[76:79], v245 offset:45056
ds_read_b128 a[224:227], v244 offset:5120
ds_read_b128 a[228:231], v244 offset:46080
ds_read_b128 a[232:235], v245 offset:5120
ds_read_b128 a[236:239], v245 offset:46080
ds_read_b128 a[240:243], v244 offset:6144
ds_read_b128 a[244:247], v244 offset:47104
ds_read_b128 a[248:251], v245 offset:6144
ds_read_b128 a[252:255], v245 offset:47104
ds_read_b128 v[108:111], v196 offset:0
ds_read_b128 v[112:115], v197 offset:0
ds_read_b128 v[116:119], v198 offset:0
ds_read_b128 v[120:123], v199 offset:0
ds_read_b128 v[124:127], v196 offset:4096
ds_read_b128 v[128:131], v197 offset:4096
ds_read_b128 v[132:135], v198 offset:4096
ds_read_b128 v[136:139], v199 offset:4096
s_waitcnt lgkmcnt(15)
v_mfma_f32_16x16x32_bf16 v[80:83], v[140:143], v[0:3], 0
s_mul_i32 s47, s2, 24576
s_add_u32 s47, s47, 16777216
s_add_u32 s40, s18, s47
s_addc_u32 s41, s19, 0
v_mfma_f32_16x16x32_bf16 v[80:83], v[144:147], v[4:7], v[80:83]
s_add_u32 m0, s51, 24576
s_add_u32 s58, s56, 32768
s_sub_u32 s58, s58, s57
buffer_load_dwordx4 v212, s[32:35], s58 offen nt lds
s_and_b32 s41, s41, 0xffff
s_mov_b32 s42, 24576
v_mfma_f32_16x16x32_bf16 v[80:83], v[148:151], v[8:11], v[80:83]
s_mov_b32 s43, 0x20000
s_mul_i32 s71, s44, 6144
v_mfma_f32_16x16x32_bf16 v[80:83], v[152:155], v[12:15], v[80:83]
v_lshlrev_b32 v252, 4, v221
v_add_u32 v253, s51, v252
v_mfma_f32_16x16x32_bf16 v[84:87], v[140:143], v[16:19], 0
buffer_load_dwordx4 v213, s[32:35], s58 offen offset:1024 nt lds
s_lshr_b32 s48, s2, 3
s_and_b32 s47, s2, 1
v_mfma_f32_16x16x32_bf16 v[84:87], v[144:147], v[20:23], v[84:87]
s_lshr_b32 s49, s2, 1
s_and_b32 s49, s49, 3
s_mul_i32 s49, s49, 7
v_mfma_f32_16x16x32_bf16 v[84:87], v[148:151], v[24:27], v[84:87]
s_lshr_b32 s62, s48, 2
s_and_b32 s50, s48, 3
v_mfma_f32_16x16x32_bf16 v[84:87], v[152:155], v[28:31], v[84:87]
s_mul_i32 s63, s47, 5
s_add_u32 s63, s63, s50
v_mfma_f32_16x16x32_bf16 v[88:91], v[140:143], v[32:35], 0
buffer_load_dwordx4 v212, s[32:35], s58 offen offset:2048 nt lds
s_lshl_b32 s77, s47, 2
s_add_u32 s77, s77, s50
v_mfma_f32_16x16x32_bf16 v[88:91], v[144:147], v[36:39], v[88:91]
s_cmp_ge_u32 s48, 28
s_cselect_b32 s62, s77, s62
s_cselect_b32 s63, 4, s63
s_cselect_b32 s50, 2, s50
s_cmp_ge_u32 s62, 7
s_cselect_b32 s70, 252, 0
v_mfma_f32_16x16x32_bf16 v[88:91], v[148:151], v[40:43], v[88:91]
s_min_u32 s62, s62, 6
s_add_u32 s62, s62, s49
v_mfma_f32_16x16x32_bf16 v[88:91], v[152:155], v[44:47], v[88:91]
buffer_load_dwordx4 v213, s[32:35], s58 offen offset:3072 nt lds
s_mul_i32 s67, s62, 0
s_mul_i32 s50, s50, 0
s_add_u32 s67, s67, s50
v_mfma_f32_16x16x32_bf16 v[92:95], v[140:143], v[48:51], 0
s_lshl_b32 s47, s63, 7
s_add_u32 s24, s12, s47
s_addc_u32 s25, s13, 0
v_mfma_f32_16x16x32_bf16 v[92:95], v[144:147], v[52:55], v[92:95]
s_and_b32 s25, s25, 0xffff
s_sub_u32 s26, 4718592, s47
v_mfma_f32_16x16x32_bf16 v[92:95], v[148:151], v[56:59], v[92:95]
s_mov_b32 s27, 0x20000
s_lshl_b32 s47, s62, 18
v_mfma_f32_16x16x32_bf16 v[92:95], v[152:155], v[60:63], v[92:95]
s_add_u32 m0, s51, 28672
s_add_u32 s58, s58, 4096
buffer_load_dwordx4 v212, s[32:35], s58 offen nt lds
s_add_u32 s20, s18, s47
s_addc_u32 s21, s19, 0
s_and_b32 s21, s21, 0xffff
s_waitcnt lgkmcnt(8)
v_mfma_f32_16x16x32_bf16 v[96:99], v[140:143], v[64:67], 0
s_mov_b32 s22, 262144
s_mov_b32 s23, 0x20000
s_mul_i32 s47, s45, 7
v_mfma_f32_16x16x32_bf16 v[96:99], v[144:147], v[68:71], v[96:99]
s_lshl_b32 s47, s47, 17
s_lshl_b32 s48, s46, 12
v_mfma_f32_16x16x32_bf16 v[96:99], v[148:151], v[72:75], v[96:99]
buffer_load_dwordx4 v213, s[32:35], s58 offen offset:1024 nt lds
s_add_u32 s47, s47, s48
s_lshl_b32 s48, s44, 10
v_mfma_f32_16x16x32_bf16 v[96:99], v[152:155], v[76:79], v[96:99]
s_add_u32 s47, s47, s48
s_add_u32 s36, s18, s47
s_addc_u32 s37, s19, 0
v_mfma_f32_16x16x32_bf16 v[100:103], v[140:143], a[224:227], 0
s_and_b32 s37, s37, 0xffff
s_mov_b32 s38, 787456
v_mfma_f32_16x16x32_bf16 v[100:103], v[144:147], a[228:231], v[100:103]
s_mov_b32 s39, 0x20000
s_mov_b32 s72, s12
v_mfma_f32_16x16x32_bf16 v[100:103], v[148:151], a[232:235], v[100:103]
buffer_load_dwordx4 v212, s[32:35], s58 offen offset:2048 nt lds
s_and_b32 s73, s13, 0xffff
s_mov_b32 s74, 4718592
s_mov_b32 s75, 0x20000
v_mfma_f32_16x16x32_bf16 v[100:103], v[152:155], a[236:239], v[100:103]
s_mul_i32 s47, s2, 144
s_mul_i32 s48, s44, 36
v_mfma_f32_16x16x32_bf16 v[104:107], v[140:143], a[240:243], 0
s_add_u32 s47, s47, s48
v_add_u32 v224, s47, v221
v_mfma_f32_16x16x32_bf16 v[104:107], v[144:147], a[244:247], v[104:107]
buffer_load_dwordx4 v213, s[32:35], s58 offen offset:3072 nt lds
v_lshlrev_b32 v224, 7, v224
v_mov_b32 v225, 0x7f000000
v_mfma_f32_16x16x32_bf16 v[104:107], v[148:151], a[248:251], v[104:107]
v_cmp_gt_u32 vcc, 36, v221
s_nop 1
v_mfma_f32_16x16x32_bf16 v[104:107], v[152:155], a[252:255], v[104:107]
v_cndmask_b32 v224, v225, v224, vcc
buffer_load_dword v251, v224, s[72:75], 0 offen
s_nop 7
v_max3_f32 v224, v80, v81, v82
v_max3_f32 v225, v84, v85, v86
v_max3_f32 v226, v88, v89, v90
v_max3_f32 v227, v92, v93, v94
v_max3_f32 v228, v96, v97, v98
v_max3_f32 v229, v100, v101, v102
v_max3_f32 v230, v104, v105, v106
v_max_f32 v224, v224, v83
v_max_f32 v225, v225, v87
v_max_f32 v226, v226, v91
v_max_f32 v227, v227, v95
v_max_f32 v228, v228, v99
v_max_f32 v229, v229, v103
v_max_f32 v230, v230, v107
v_mov_b32 v232, v224
v_mov_b32 v233, v225
v_mov_b32 v234, v226
v_mov_b32 v235, v227
v_mov_b32 v236, v228
v_mov_b32 v237, v229
v_mov_b32 v238, v230
s_nop 1
v_permlane32_swap_b32 v224, v232
v_permlane32_swap_b32 v225, v233
v_permlane32_swap_b32 v226, v234
v_permlane32_swap_b32 v227, v235
v_permlane32_swap_b32 v228, v236
v_permlane32_swap_b32 v229, v237
v_permlane32_swap_b32 v230, v238
s_nop 1
v_max_f32 v224, v224, v232
v_max_f32 v225, v225, v233
v_max_f32 v226, v226, v234
v_max_f32 v227, v227, v235
v_max_f32 v228, v228, v236
v_max_f32 v229, v229, v237
v_max_f32 v230, v230, v238
v_mov_b32 v232, v224
v_mov_b32 v233, v225
v_mov_b32 v234, v226
v_mov_b32 v235, v227
v_mov_b32 v236, v228
v_mov_b32 v237, v229
v_mov_b32 v238, v230
s_nop 1
v_permlane16_swap_b32 v224, v232
v_permlane16_swap_b32 v225, v233
v_permlane16_swap_b32 v226, v234
v_permlane16_swap_b32 v227, v235
v_permlane16_swap_b32 v228, v236
v_permlane16_swap_b32 v229, v237
v_permlane16_swap_b32 v230, v238
s_nop 1
v_max_f32 v224, v224, v232
v_max_f32 v225, v225, v233
v_max_f32 v226, v226, v234
v_max_f32 v227, v227, v235
v_max_f32 v228, v228, v236
v_max_f32 v229, v229, v237
v_max_f32 v230, v230, v238
v_sub_f32 v80, 0, v224
v_sub_f32 v81, 0, v224
v_sub_f32 v82, 0, v224
v_sub_f32 v83, 0, v224
v_sub_f32 v84, 0, v225
v_sub_f32 v85, 0, v225
v_sub_f32 v86, 0, v225
v_sub_f32 v87, 0, v225
v_sub_f32 v88, 0, v226
v_sub_f32 v89, 0, v226
v_sub_f32 v90, 0, v226
v_sub_f32 v91, 0, v226
v_sub_f32 v92, 0, v227
v_sub_f32 v93, 0, v227
v_sub_f32 v94, 0, v227
v_sub_f32 v95, 0, v227
v_sub_f32 v96, 0, v228
v_sub_f32 v97, 0, v228
v_sub_f32 v98, 0, v228
v_sub_f32 v99, 0, v228
v_sub_f32 v100, 0, v229
v_sub_f32 v101, 0, v229
v_sub_f32 v102, 0, v229
v_sub_f32 v103, 0, v229
v_sub_f32 v104, 0, v230
v_sub_f32 v105, 0, v230
v_sub_f32 v106, 0, v230
v_sub_f32 v107, 0, v230
s_waitcnt lgkmcnt(0)
L_main_entry:
v_mov_b32 v214, 0
v_mov_b32 v215, 0
v_mov_b32 v216, 0
v_mov_b32 v217, 0
v_mov_b32 v218, 0
v_mov_b32 v219, 0
v_mov_b32 v220, 0
v_mfma_f32_16x16x32_bf16 v[172:175], v[108:111], v[0:3], v[80:83]
v_mfma_f32_16x16x32_bf16 v[172:175], v[112:115], v[4:7], v[172:175]
v_mfma_f32_16x16x32_bf16 v[172:175], v[116:119], v[8:11], v[172:175]
v_mfma_f32_16x16x32_bf16 v[172:175], v[120:123], v[12:15], v[172:175]
v_mfma_f32_16x16x32_bf16 v[176:179], v[124:127], v[0:3], v[80:83]
v_mfma_f32_16x16x32_bf16 v[176:179], v[128:131], v[4:7], v[176:179]
v_mfma_f32_16x16x32_bf16 v[176:179], v[132:135], v[8:11], v[176:179]
v_mfma_f32_16x16x32_bf16 v[176:179], v[136:139], v[12:15], v[176:179]
s_nop 7
s_waitcnt vmcnt(17)
v_mfma_f32_16x16x32_bf16 v[180:183], v[108:111], v[16:19], v[84:87]
v_exp_f32 v172, v172
v_exp_f32 v173, v173
v_exp_f32 v174, v174
ds_read_b64_tr_b16 v[140:141], v200 offset:0
ds_read_b64_tr_b16 v[142:143], v200 offset:4096
v_mfma_f32_16x16x32_bf16 v[180:183], v[112:115], v[20:23], v[180:183]
v_add_f32 v214, v214, v172
v_exp_f32 v175, v175
ds_read_b64_tr_b16 v[144:145], v201 offset:0
ds_read_b64_tr_b16 v[146:147], v201 offset:4096
s_add_u32 m0, s51, 0
s_add_u32 s58, s56, 65536
s_add_u32 s58, s58, s57
buffer_load_dwordx4 v208, s[28:31], s58 offen nt lds
v_mfma_f32_16x16x32_bf16 v[180:183], v[116:119], v[24:27], v[180:183]
v_add_f32 v214, v214, v173
v_cvt_pk_bf16_f32 v188, v172, v173
v_exp_f32 v176, v176
ds_read_b64_tr_b16 v[148:149], v202 offset:0
ds_read_b64_tr_b16 v[150:151], v202 offset:4096
v_mfma_f32_16x16x32_bf16 v[180:183], v[120:123], v[28:31], v[180:183]
v_add_f32 v214, v214, v174
v_exp_f32 v177, v177
ds_read_b64_tr_b16 v[152:153], v203 offset:0
ds_read_b64_tr_b16 v[154:155], v203 offset:4096
buffer_load_dwordx4 v209, s[28:31], s58 offen offset:1024 nt lds
v_mfma_f32_16x16x32_bf16 v[184:187], v[124:127], v[16:19], v[84:87]
v_add_f32 v214, v214, v175
v_cvt_pk_bf16_f32 v189, v174, v175
v_exp_f32 v178, v178
ds_read_b64_tr_b16 v[156:157], v204 offset:0
ds_read_b64_tr_b16 v[158:159], v204 offset:4096
v_mfma_f32_16x16x32_bf16 v[184:187], v[128:131], v[20:23], v[184:187]
v_add_f32 v214, v214, v176
v_exp_f32 v179, v179
ds_read_b64_tr_b16 v[160:161], v205 offset:0
ds_read_b64_tr_b16 v[162:163], v205 offset:4096
v_mfma_f32_16x16x32_bf16 v[184:187], v[132:135], v[24:27], v[184:187]
v_add_f32 v214, v214, v177
v_cvt_pk_bf16_f32 v190, v176, v177
v_add_f32 v214, v214, v178
ds_read_b64_tr_b16 v[164:165], v206 offset:0
ds_read_b64_tr_b16 v[166:167], v206 offset:4096
buffer_load_dwordx4 v210, s[28:31], s58 offen offset:2048 nt lds
v_mfma_f32_16x16x32_bf16 v[184:187], v[136:139], v[28:31], v[184:187]
v_cvt_pk_bf16_f32 v191, v178, v179
v_add_f32 v214, v214, v179
ds_read_b64_tr_b16 v[168:169], v207 offset:0
ds_read_b64_tr_b16 v[170:171], v207 offset:4096
s_waitcnt lgkmcnt(8)
v_mfma_f32_16x16x32_bf16 v[172:175], v[108:111], v[32:35], v[88:91]
v_exp_f32 v180, v180
v_mfma_f32_16x16x32_bf16 v[172:175], v[112:115], v[36:39], v[172:175]
buffer_load_dwordx4 v211, s[28:31], s58 offen offset:3072 nt lds
v_exp_f32 v181, v181
v_mfma_f32_16x16x32_bf16 v[172:175], v[116:119], v[40:43], v[172:175]
v_exp_f32 v182, v182
v_mfma_f32_16x16x32_bf16 v[172:175], v[120:123], v[44:47], v[172:175]
v_exp_f32 v183, v183
v_mfma_f32_16x16x32_bf16 a[0:3], v[140:143], v[188:191], 0
v_add_f32 v215, v215, v180
v_cvt_pk_bf16_f32 v192, v180, v181
v_mfma_f32_16x16x32_bf16 a[4:7], v[144:147], v[188:191], 0
v_exp_f32 v184, v184
v_mfma_f32_16x16x32_bf16 a[8:11], v[148:151], v[188:191], 0
s_add_u32 m0, s51, 4096
s_add_u32 s58, s58, 4096
buffer_load_dwordx4 v208, s[28:31], s58 offen nt lds
v_add_f32 v215, v215, v181
v_add_f32 v215, v215, v182
v_mfma_f32_16x16x32_bf16 a[12:15], v[152:155], v[188:191], 0
s_waitcnt lgkmcnt(0)
v_exp_f32 v185, v185
v_mfma_f32_16x16x32_bf16 v[176:179], v[124:127], v[32:35], v[88:91]
v_add_f32 v215, v215, v183
v_cvt_pk_bf16_f32 v193, v182, v183
v_mfma_f32_16x16x32_bf16 v[176:179], v[128:131], v[36:39], v[176:179]
v_exp_f32 v186, v186
v_mfma_f32_16x16x32_bf16 v[176:179], v[132:135], v[40:43], v[176:179]
v_add_f32 v215, v215, v184
v_add_f32 v215, v215, v185
v_mfma_f32_16x16x32_bf16 v[176:179], v[136:139], v[44:47], v[176:179]
buffer_load_dwordx4 v209, s[28:31], s58 offen offset:1024 nt lds
v_exp_f32 v187, v187
v_mfma_f32_16x16x32_bf16 a[16:19], v[156:159], v[188:191], 0
v_cvt_pk_bf16_f32 v194, v184, v185
v_add_f32 v215, v215, v186
v_mfma_f32_16x16x32_bf16 a[20:23], v[160:163], v[188:191], 0
v_cvt_pk_bf16_f32 v195, v186, v187
v_add_f32 v215, v215, v187
v_mfma_f32_16x16x32_bf16 a[24:27], v[164:167], v[188:191], 0
v_mfma_f32_16x16x32_bf16 a[28:31], v[168:171], v[188:191], 0
v_mfma_f32_16x16x32_bf16 v[180:183], v[108:111], v[48:51], v[92:95]
v_exp_f32 v172, v172
v_mfma_f32_16x16x32_bf16 v[180:183], v[112:115], v[52:55], v[180:183]
buffer_load_dwordx4 v210, s[28:31], s58 offen offset:2048 nt lds
v_exp_f32 v173, v173
v_mfma_f32_16x16x32_bf16 v[180:183], v[116:119], v[56:59], v[180:183]
v_exp_f32 v174, v174
v_mfma_f32_16x16x32_bf16 v[180:183], v[120:123], v[60:63], v[180:183]
v_exp_f32 v175, v175
v_mfma_f32_16x16x32_bf16 a[32:35], v[140:143], v[192:195], 0
v_add_f32 v216, v216, v172
v_cvt_pk_bf16_f32 v188, v172, v173
v_mfma_f32_16x16x32_bf16 a[36:39], v[144:147], v[192:195], 0
v_exp_f32 v176, v176
v_mfma_f32_16x16x32_bf16 a[40:43], v[148:151], v[192:195], 0
v_add_f32 v216, v216, v173
v_add_f32 v216, v216, v174
v_mfma_f32_16x16x32_bf16 a[44:47], v[152:155], v[192:195], 0
v_exp_f32 v177, v177
v_mfma_f32_16x16x32_bf16 v[184:187], v[124:127], v[48:51], v[92:95]
v_add_f32 v216, v216, v175
v_cvt_pk_bf16_f32 v189, v174, v175
v_mfma_f32_16x16x32_bf16 v[184:187], v[128:131], v[52:55], v[184:187]
buffer_load_dwordx4 v211, s[28:31], s58 offen offset:3072 nt lds
v_exp_f32 v178, v178
v_mfma_f32_16x16x32_bf16 v[184:187], v[132:135], v[56:59], v[184:187]
v_add_f32 v216, v216, v176
v_add_f32 v216, v216, v177
v_mfma_f32_16x16x32_bf16 v[184:187], v[136:139], v[60:63], v[184:187]
v_exp_f32 v179, v179
v_mfma_f32_16x16x32_bf16 a[48:51], v[156:159], v[192:195], 0
v_cvt_pk_bf16_f32 v190, v176, v177
v_add_f32 v216, v216, v178
v_mfma_f32_16x16x32_bf16 a[52:55], v[160:163], v[192:195], 0
v_cvt_pk_bf16_f32 v191, v178, v179
v_add_f32 v216, v216, v179
v_mfma_f32_16x16x32_bf16 a[56:59], v[164:167], v[192:195], 0
v_mfma_f32_16x16x32_bf16 a[60:63], v[168:171], v[192:195], 0
v_mfma_f32_16x16x32_bf16 v[172:175], v[108:111], v[64:67], v[96:99]
v_exp_f32 v180, v180
v_mfma_f32_16x16x32_bf16 v[172:175], v[112:115], v[68:71], v[172:175]
s_add_u32 m0, s51, 16384
s_add_u32 s58, s56, 65536
s_add_u32 s58, s58, s57
buffer_load_dwordx4 v212, s[32:35], s58 offen nt lds
v_exp_f32 v181, v181
v_mfma_f32_16x16x32_bf16 v[172:175], v[116:119], v[72:75], v[172:175]
v_exp_f32 v182, v182
v_mfma_f32_16x16x32_bf16 v[172:175], v[120:123], v[76:79], v[172:175]
v_exp_f32 v183, v183
v_mfma_f32_16x16x32_bf16 a[64:67], v[140:143], v[188:191], 0
v_add_f32 v217, v217, v180
v_cvt_pk_bf16_f32 v192, v180, v181
v_mfma_f32_16x16x32_bf16 a[68:71], v[144:147], v[188:191], 0
v_exp_f32 v184, v184
v_mfma_f32_16x16x32_bf16 a[72:75], v[148:151], v[188:191], 0
v_add_f32 v217, v217, v181
v_add_f32 v217, v217, v182
v_mfma_f32_16x16x32_bf16 a[76:79], v[152:155], v[188:191], 0
v_exp_f32 v185, v185
v_mfma_f32_16x16x32_bf16 v[176:179], v[124:127], v[64:67], v[96:99]
v_add_f32 v217, v217, v183
v_cvt_pk_bf16_f32 v193, v182, v183
v_mfma_f32_16x16x32_bf16 v[176:179], v[128:131], v[68:71], v[176:179]
buffer_load_dwordx4 v213, s[32:35], s58 offen offset:1024 nt lds
v_exp_f32 v186, v186
v_mfma_f32_16x16x32_bf16 v[176:179], v[132:135], v[72:75], v[176:179]
v_add_f32 v217, v217, v184
v_add_f32 v217, v217, v185
v_mfma_f32_16x16x32_bf16 v[176:179], v[136:139], v[76:79], v[176:179]
v_exp_f32 v187, v187
v_mfma_f32_16x16x32_bf16 a[80:83], v[156:159], v[188:191], 0
v_cvt_pk_bf16_f32 v194, v184, v185
v_add_f32 v217, v217, v186
v_mfma_f32_16x16x32_bf16 a[84:87], v[160:163], v[188:191], 0
v_cvt_pk_bf16_f32 v195, v186, v187
v_add_f32 v217, v217, v187
v_mfma_f32_16x16x32_bf16 a[88:91], v[164:167], v[188:191], 0
v_mfma_f32_16x16x32_bf16 a[92:95], v[168:171], v[188:191], 0
v_mfma_f32_16x16x32_bf16 v[180:183], v[108:111], a[224:227], v[100:103]
v_exp_f32 v172, v172
v_mfma_f32_16x16x32_bf16 v[180:183], v[112:115], a[228:231], v[180:183]
buffer_load_dwordx4 v212, s[32:35], s58 offen offset:2048 nt lds
v_exp_f32 v173, v173
v_mfma_f32_16x16x32_bf16 v[180:183], v[116:119], a[232:235], v[180:183]
v_exp_f32 v174, v174
v_mfma_f32_16x16x32_bf16 v[180:183], v[120:123], a[236:239], v[180:183]
v_exp_f32 v175, v175
v_mfma_f32_16x16x32_bf16 a[96:99], v[140:143], v[192:195], 0
v_add_f32 v218, v218, v172
v_cvt_pk_bf16_f32 v188, v172, v173
v_mfma_f32_16x16x32_bf16 a[100:103], v[144:147], v[192:195], 0
v_exp_f32 v176, v176
v_mfma_f32_16x16x32_bf16 a[104:107], v[148:151], v[192:195], 0
v_add_f32 v218, v218, v173
v_add_f32 v218, v218, v174
v_mfma_f32_16x16x32_bf16 a[108:111], v[152:155], v[192:195], 0
v_exp_f32 v177, v177
v_mfma_f32_16x16x32_bf16 v[184:187], v[124:127], a[224:227], v[100:103]
v_add_f32 v218, v218, v175
v_cvt_pk_bf16_f32 v189, v174, v175
v_mfma_f32_16x16x32_bf16 v[184:187], v[128:131], a[228:231], v[184:187]
buffer_load_dwordx4 v213, s[32:35], s58 offen offset:3072 nt lds
v_exp_f32 v178, v178
v_mfma_f32_16x16x32_bf16 v[184:187], v[132:135], a[232:235], v[184:187]
v_add_f32 v218, v218, v176
v_add_f32 v218, v218, v177
v_mfma_f32_16x16x32_bf16 v[184:187], v[136:139], a[236:239], v[184:187]
v_exp_f32 v179, v179
v_mfma_f32_16x16x32_bf16 a[112:115], v[156:159], v[192:195], 0
v_cvt_pk_bf16_f32 v190, v176, v177
v_add_f32 v218, v218, v178
v_mfma_f32_16x16x32_bf16 a[116:119], v[160:163], v[192:195], 0
v_cvt_pk_bf16_f32 v191, v178, v179
v_add_f32 v218, v218, v179
v_mfma_f32_16x16x32_bf16 a[120:123], v[164:167], v[192:195], 0
v_mfma_f32_16x16x32_bf16 a[124:127], v[168:171], v[192:195], 0
s_waitcnt vmcnt(21)
v_mfma_f32_16x16x32_bf16 v[172:175], v[108:111], a[240:243], v[104:107]
ds_read_b128 v[108:111], v196 offset:8192
v_exp_f32 v180, v180
v_mfma_f32_16x16x32_bf16 v[172:175], v[112:115], a[244:247], v[172:175]
ds_read_b128 v[112:115], v197 offset:8192
s_add_u32 m0, s51, 20480
s_add_u32 s58, s58, 4096
buffer_load_dwordx4 v212, s[32:35], s58 offen nt lds
v_exp_f32 v181, v181
v_mfma_f32_16x16x32_bf16 v[172:175], v[116:119], a[248:251], v[172:175]
ds_read_b128 v[116:119], v198 offset:8192
v_exp_f32 v182, v182
v_mfma_f32_16x16x32_bf16 v[172:175], v[120:123], a[252:255], v[172:175]
ds_read_b128 v[120:123], v199 offset:8192
v_exp_f32 v183, v183
v_mfma_f32_16x16x32_bf16 a[128:131], v[140:143], v[188:191], 0
v_add_f32 v219, v219, v180
v_cvt_pk_bf16_f32 v192, v180, v181
v_mfma_f32_16x16x32_bf16 a[132:135], v[144:147], v[188:191], 0
v_exp_f32 v184, v184
v_mfma_f32_16x16x32_bf16 a[136:139], v[148:151], v[188:191], 0
v_add_f32 v219, v219, v181
v_add_f32 v219, v219, v182
v_mfma_f32_16x16x32_bf16 a[140:143], v[152:155], v[188:191], 0
v_exp_f32 v185, v185
v_mfma_f32_16x16x32_bf16 v[176:179], v[124:127], a[240:243], v[104:107]
ds_read_b128 v[124:127], v196 offset:12288
v_add_f32 v219, v219, v183
v_cvt_pk_bf16_f32 v193, v182, v183
v_mfma_f32_16x16x32_bf16 v[176:179], v[128:131], a[244:247], v[176:179]
ds_read_b128 v[128:131], v197 offset:12288
buffer_load_dwordx4 v213, s[32:35], s58 offen offset:1024 nt lds
v_exp_f32 v186, v186
v_mfma_f32_16x16x32_bf16 v[176:179], v[132:135], a[248:251], v[176:179]
ds_read_b128 v[132:135], v198 offset:12288
v_add_f32 v219, v219, v184
v_add_f32 v219, v219, v185
v_mfma_f32_16x16x32_bf16 v[176:179], v[136:139], a[252:255], v[176:179]
ds_read_b128 v[136:139], v199 offset:12288
v_exp_f32 v187, v187
v_mfma_f32_16x16x32_bf16 a[144:147], v[156:159], v[188:191], 0
v_cvt_pk_bf16_f32 v194, v184, v185
v_add_f32 v219, v219, v186
v_mfma_f32_16x16x32_bf16 a[148:151], v[160:163], v[188:191], 0
v_cvt_pk_bf16_f32 v195, v186, v187
v_add_f32 v219, v219, v187
v_mfma_f32_16x16x32_bf16 a[152:155], v[164:167], v[188:191], 0
v_mfma_f32_16x16x32_bf16 a[156:159], v[168:171], v[188:191], 0
s_waitcnt lgkmcnt(4)
v_mfma_f32_16x16x32_bf16 v[180:183], v[108:111], v[0:3], v[80:83]
v_exp_f32 v172, v172
v_mfma_f32_16x16x32_bf16 v[180:183], v[112:115], v[4:7], v[180:183]
buffer_load_dwordx4 v212, s[32:35], s58 offen offset:2048 nt lds
v_exp_f32 v173, v173
v_mfma_f32_16x16x32_bf16 v[180:183], v[116:119], v[8:11], v[180:183]
v_exp_f32 v174, v174
v_mfma_f32_16x16x32_bf16 v[180:183], v[120:123], v[12:15], v[180:183]
s_waitcnt lgkmcnt(0)
v_exp_f32 v175, v175
v_mfma_f32_16x16x32_bf16 a[160:163], v[140:143], v[192:195], 0
v_add_f32 v220, v220, v172
v_cvt_pk_bf16_f32 v188, v172, v173
v_mfma_f32_16x16x32_bf16 a[164:167], v[144:147], v[192:195], 0
v_exp_f32 v176, v176
v_mfma_f32_16x16x32_bf16 a[168:171], v[148:151], v[192:195], 0
v_add_f32 v220, v220, v173
v_add_f32 v220, v220, v174
v_mfma_f32_16x16x32_bf16 a[172:175], v[152:155], v[192:195], 0
v_exp_f32 v177, v177
v_mfma_f32_16x16x32_bf16 v[184:187], v[124:127], v[0:3], v[80:83]
v_add_f32 v220, v220, v175
v_cvt_pk_bf16_f32 v189, v174, v175
v_mfma_f32_16x16x32_bf16 v[184:187], v[128:131], v[4:7], v[184:187]
buffer_load_dwordx4 v213, s[32:35], s58 offen offset:3072 nt lds
v_exp_f32 v178, v178
v_mfma_f32_16x16x32_bf16 v[184:187], v[132:135], v[8:11], v[184:187]
v_add_f32 v220, v220, v176
v_add_f32 v220, v220, v177
v_mfma_f32_16x16x32_bf16 v[184:187], v[136:139], v[12:15], v[184:187]
v_exp_f32 v179, v179
v_mfma_f32_16x16x32_bf16 a[176:179], v[156:159], v[192:195], 0
v_cvt_pk_bf16_f32 v190, v176, v177
v_add_f32 v220, v220, v178
v_mfma_f32_16x16x32_bf16 a[180:183], v[160:163], v[192:195], 0
v_cvt_pk_bf16_f32 v191, v178, v179
v_add_f32 v220, v220, v179
v_mfma_f32_16x16x32_bf16 a[184:187], v[164:167], v[192:195], 0
v_mfma_f32_16x16x32_bf16 a[188:191], v[168:171], v[192:195], 0
s_waitcnt vmcnt(17)
v_mfma_f32_16x16x32_bf16 v[172:175], v[108:111], v[16:19], v[84:87]
v_exp_f32 v180, v180
v_mfma_f32_16x16x32_bf16 v[172:175], v[112:115], v[20:23], v[172:175]
s_add_u32 m0, s51, 8192
s_add_u32 s58, s56, 98304
s_sub_u32 s58, s58, s57
buffer_load_dwordx4 v208, s[28:31], s58 offen nt lds
v_exp_f32 v181, v181
v_mfma_f32_16x16x32_bf16 v[172:175], v[116:119], v[24:27], v[172:175]
v_exp_f32 v182, v182
v_mfma_f32_16x16x32_bf16 v[172:175], v[120:123], v[28:31], v[172:175]
v_exp_f32 v183, v183
v_mfma_f32_16x16x32_bf16 a[192:195], v[140:143], v[188:191], 0
ds_read_b64_tr_b16 v[140:141], v200 offset:8192
ds_read_b64_tr_b16 v[142:143], v200 offset:12288
v_add_f32 v214, v214, v180
v_cvt_pk_bf16_f32 v192, v180, v181
v_mfma_f32_16x16x32_bf16 a[196:199], v[144:147], v[188:191], 0
ds_read_b64_tr_b16 v[144:145], v201 offset:8192
ds_read_b64_tr_b16 v[146:147], v201 offset:12288
v_exp_f32 v184, v184
v_mfma_f32_16x16x32_bf16 a[200:203], v[148:151], v[188:191], 0
ds_read_b64_tr_b16 v[148:149], v202 offset:8192
ds_read_b64_tr_b16 v[150:151], v202 offset:12288
buffer_load_dwordx4 v209, s[28:31], s58 offen offset:1024 nt lds
v_add_f32 v214, v214, v181
v_add_f32 v214, v214, v182
v_mfma_f32_16x16x32_bf16 a[204:207], v[152:155], v[188:191], 0
ds_read_b64_tr_b16 v[152:153], v203 offset:8192
ds_read_b64_tr_b16 v[154:155], v203 offset:12288
v_exp_f32 v185, v185
v_mfma_f32_16x16x32_bf16 v[176:179], v[124:127], v[16:19], v[84:87]
v_add_f32 v214, v214, v183
v_cvt_pk_bf16_f32 v193, v182, v183
v_mfma_f32_16x16x32_bf16 v[176:179], v[128:131], v[20:23], v[176:179]
v_exp_f32 v186, v186
v_mfma_f32_16x16x32_bf16 v[176:179], v[132:135], v[24:27], v[176:179]
v_add_f32 v214, v214, v184
v_add_f32 v214, v214, v185
v_mfma_f32_16x16x32_bf16 v[176:179], v[136:139], v[28:31], v[176:179]
buffer_load_dwordx4 v210, s[28:31], s58 offen offset:2048 nt lds
v_exp_f32 v187, v187
v_mfma_f32_16x16x32_bf16 a[208:211], v[156:159], v[188:191], 0
ds_read_b64_tr_b16 v[156:157], v204 offset:8192
ds_read_b64_tr_b16 v[158:159], v204 offset:12288
v_cvt_pk_bf16_f32 v194, v184, v185
v_add_f32 v214, v214, v186
v_mfma_f32_16x16x32_bf16 a[212:215], v[160:163], v[188:191], 0
ds_read_b64_tr_b16 v[160:161], v205 offset:8192
ds_read_b64_tr_b16 v[162:163], v205 offset:12288
v_cvt_pk_bf16_f32 v195, v186, v187
v_add_f32 v214, v214, v187
v_mfma_f32_16x16x32_bf16 a[216:219], v[164:167], v[188:191], 0
ds_read_b64_tr_b16 v[164:165], v206 offset:8192
ds_read_b64_tr_b16 v[166:167], v206 offset:12288
v_mfma_f32_16x16x32_bf16 a[220:223], v[168:171], v[188:191], 0
ds_read_b64_tr_b16 v[168:169], v207 offset:8192
ds_read_b64_tr_b16 v[170:171], v207 offset:12288
s_waitcnt lgkmcnt(8)
v_mfma_f32_16x16x32_bf16 v[180:183], v[108:111], v[32:35], v[88:91]
v_exp_f32 v172, v172
v_mfma_f32_16x16x32_bf16 v[180:183], v[112:115], v[36:39], v[180:183]
buffer_load_dwordx4 v211, s[28:31], s58 offen offset:3072 nt lds
v_exp_f32 v173, v173
v_mfma_f32_16x16x32_bf16 v[180:183], v[116:119], v[40:43], v[180:183]
v_exp_f32 v174, v174
v_mfma_f32_16x16x32_bf16 v[180:183], v[120:123], v[44:47], v[180:183]
v_exp_f32 v175, v175
v_mfma_f32_16x16x32_bf16 a[0:3], v[140:143], v[192:195], a[0:3]
v_add_f32 v215, v215, v172
v_cvt_pk_bf16_f32 v188, v172, v173
v_mfma_f32_16x16x32_bf16 a[4:7], v[144:147], v[192:195], a[4:7]
v_exp_f32 v176, v176
v_mfma_f32_16x16x32_bf16 a[8:11], v[148:151], v[192:195], a[8:11]
s_add_u32 m0, s51, 12288
s_add_u32 s58, s58, 4096
buffer_load_dwordx4 v208, s[28:31], s58 offen nt lds
v_add_f32 v215, v215, v173
v_add_f32 v215, v215, v174
v_mfma_f32_16x16x32_bf16 a[12:15], v[152:155], v[192:195], a[12:15]
s_waitcnt lgkmcnt(0)
v_exp_f32 v177, v177
v_mfma_f32_16x16x32_bf16 v[184:187], v[124:127], v[32:35], v[88:91]
v_add_f32 v215, v215, v175
v_cvt_pk_bf16_f32 v189, v174, v175
v_mfma_f32_16x16x32_bf16 v[184:187], v[128:131], v[36:39], v[184:187]
v_exp_f32 v178, v178
v_mfma_f32_16x16x32_bf16 v[184:187], v[132:135], v[40:43], v[184:187]
v_add_f32 v215, v215, v176
v_add_f32 v215, v215, v177
v_mfma_f32_16x16x32_bf16 v[184:187], v[136:139], v[44:47], v[184:187]
buffer_load_dwordx4 v209, s[28:31], s58 offen offset:1024 nt lds
v_exp_f32 v179, v179
v_mfma_f32_16x16x32_bf16 a[16:19], v[156:159], v[192:195], a[16:19]
v_cvt_pk_bf16_f32 v190, v176, v177
v_add_f32 v215, v215, v178
v_mfma_f32_16x16x32_bf16 a[20:23], v[160:163], v[192:195], a[20:23]
v_cvt_pk_bf16_f32 v191, v178, v179
v_add_f32 v215, v215, v179
v_mfma_f32_16x16x32_bf16 a[24:27], v[164:167], v[192:195], a[24:27]
v_mfma_f32_16x16x32_bf16 a[28:31], v[168:171], v[192:195], a[28:31]
v_mfma_f32_16x16x32_bf16 v[172:175], v[108:111], v[48:51], v[92:95]
v_exp_f32 v180, v180
v_mfma_f32_16x16x32_bf16 v[172:175], v[112:115], v[52:55], v[172:175]
buffer_load_dwordx4 v210, s[28:31], s58 offen offset:2048 nt lds
v_exp_f32 v181, v181
v_mfma_f32_16x16x32_bf16 v[172:175], v[116:119], v[56:59], v[172:175]
v_exp_f32 v182, v182
v_mfma_f32_16x16x32_bf16 v[172:175], v[120:123], v[60:63], v[172:175]
v_exp_f32 v183, v183
v_mfma_f32_16x16x32_bf16 a[32:35], v[140:143], v[188:191], a[32:35]
v_add_f32 v216, v216, v180
v_cvt_pk_bf16_f32 v192, v180, v181
v_mfma_f32_16x16x32_bf16 a[36:39], v[144:147], v[188:191], a[36:39]
v_exp_f32 v184, v184
v_mfma_f32_16x16x32_bf16 a[40:43], v[148:151], v[188:191], a[40:43]
v_add_f32 v216, v216, v181
v_add_f32 v216, v216, v182
v_mfma_f32_16x16x32_bf16 a[44:47], v[152:155], v[188:191], a[44:47]
v_exp_f32 v185, v185
v_mfma_f32_16x16x32_bf16 v[176:179], v[124:127], v[48:51], v[92:95]
v_add_f32 v216, v216, v183
v_cvt_pk_bf16_f32 v193, v182, v183
v_mfma_f32_16x16x32_bf16 v[176:179], v[128:131], v[52:55], v[176:179]
buffer_load_dwordx4 v211, s[28:31], s58 offen offset:3072 nt lds
v_exp_f32 v186, v186
v_mfma_f32_16x16x32_bf16 v[176:179], v[132:135], v[56:59], v[176:179]
v_add_f32 v216, v216, v184
v_add_f32 v216, v216, v185
v_mfma_f32_16x16x32_bf16 v[176:179], v[136:139], v[60:63], v[176:179]
v_exp_f32 v187, v187
v_mfma_f32_16x16x32_bf16 a[48:51], v[156:159], v[188:191], a[48:51]
v_cvt_pk_bf16_f32 v194, v184, v185
v_add_f32 v216, v216, v186
v_mfma_f32_16x16x32_bf16 a[52:55], v[160:163], v[188:191], a[52:55]
v_cvt_pk_bf16_f32 v195, v186, v187
v_add_f32 v216, v216, v187
v_mfma_f32_16x16x32_bf16 a[56:59], v[164:167], v[188:191], a[56:59]
v_mfma_f32_16x16x32_bf16 a[60:63], v[168:171], v[188:191], a[60:63]
v_mfma_f32_16x16x32_bf16 v[180:183], v[108:111], v[64:67], v[96:99]
v_exp_f32 v172, v172
v_mfma_f32_16x16x32_bf16 v[180:183], v[112:115], v[68:71], v[180:183]
s_add_u32 m0, s51, 24576
s_add_u32 s58, s56, 98304
s_sub_u32 s58, s58, s57
buffer_load_dwordx4 v212, s[32:35], s58 offen nt lds
v_exp_f32 v173, v173
v_mfma_f32_16x16x32_bf16 v[180:183], v[116:119], v[72:75], v[180:183]
v_exp_f32 v174, v174
v_mfma_f32_16x16x32_bf16 v[180:183], v[120:123], v[76:79], v[180:183]
v_exp_f32 v175, v175
v_mfma_f32_16x16x32_bf16 a[64:67], v[140:143], v[192:195], a[64:67]
v_add_f32 v217, v217, v172
v_cvt_pk_bf16_f32 v188, v172, v173
v_mfma_f32_16x16x32_bf16 a[68:71], v[144:147], v[192:195], a[68:71]
v_exp_f32 v176, v176
v_mfma_f32_16x16x32_bf16 a[72:75], v[148:151], v[192:195], a[72:75]
v_add_f32 v217, v217, v173
v_add_f32 v217, v217, v174
v_mfma_f32_16x16x32_bf16 a[76:79], v[152:155], v[192:195], a[76:79]
v_exp_f32 v177, v177
v_mfma_f32_16x16x32_bf16 v[184:187], v[124:127], v[64:67], v[96:99]
v_add_f32 v217, v217, v175
v_cvt_pk_bf16_f32 v189, v174, v175
v_mfma_f32_16x16x32_bf16 v[184:187], v[128:131], v[68:71], v[184:187]
buffer_load_dwordx4 v213, s[32:35], s58 offen offset:1024 nt lds
v_exp_f32 v178, v178
v_mfma_f32_16x16x32_bf16 v[184:187], v[132:135], v[72:75], v[184:187]
v_add_f32 v217, v217, v176
v_add_f32 v217, v217, v177
v_mfma_f32_16x16x32_bf16 v[184:187], v[136:139], v[76:79], v[184:187]
v_exp_f32 v179, v179
v_mfma_f32_16x16x32_bf16 a[80:83], v[156:159], v[192:195], a[80:83]
v_cvt_pk_bf16_f32 v190, v176, v177
v_add_f32 v217, v217, v178
v_mfma_f32_16x16x32_bf16 a[84:87], v[160:163], v[192:195], a[84:87]
v_cvt_pk_bf16_f32 v191, v178, v179
v_add_f32 v217, v217, v179
v_mfma_f32_16x16x32_bf16 a[88:91], v[164:167], v[192:195], a[88:91]
v_mfma_f32_16x16x32_bf16 a[92:95], v[168:171], v[192:195], a[92:95]
v_mfma_f32_16x16x32_bf16 v[172:175], v[108:111], a[224:227], v[100:103]
v_exp_f32 v180, v180
v_mfma_f32_16x16x32_bf16 v[172:175], v[112:115], a[228:231], v[172:175]
buffer_load_dwordx4 v212, s[32:35], s58 offen offset:2048 nt lds
v_exp_f32 v181, v181
v_mfma_f32_16x16x32_bf16 v[172:175], v[116:119], a[232:235], v[172:175]
v_exp_f32 v182, v182
v_mfma_f32_16x16x32_bf16 v[172:175], v[120:123], a[236:239], v[172:175]
v_exp_f32 v183, v183
v_mfma_f32_16x16x32_bf16 a[96:99], v[140:143], v[188:191], a[96:99]
v_add_f32 v218, v218, v180
v_cvt_pk_bf16_f32 v192, v180, v181
v_mfma_f32_16x16x32_bf16 a[100:103], v[144:147], v[188:191], a[100:103]
v_exp_f32 v184, v184
v_mfma_f32_16x16x32_bf16 a[104:107], v[148:151], v[188:191], a[104:107]
v_add_f32 v218, v218, v181
v_add_f32 v218, v218, v182
v_mfma_f32_16x16x32_bf16 a[108:111], v[152:155], v[188:191], a[108:111]
v_exp_f32 v185, v185
v_mfma_f32_16x16x32_bf16 v[176:179], v[124:127], a[224:227], v[100:103]
v_add_f32 v218, v218, v183
v_cvt_pk_bf16_f32 v193, v182, v183
v_mfma_f32_16x16x32_bf16 v[176:179], v[128:131], a[228:231], v[176:179]
buffer_load_dwordx4 v213, s[32:35], s58 offen offset:3072 nt lds
v_exp_f32 v186, v186
v_mfma_f32_16x16x32_bf16 v[176:179], v[132:135], a[232:235], v[176:179]
v_add_f32 v218, v218, v184
v_add_f32 v218, v218, v185
v_mfma_f32_16x16x32_bf16 v[176:179], v[136:139], a[236:239], v[176:179]
v_exp_f32 v187, v187
v_mfma_f32_16x16x32_bf16 a[112:115], v[156:159], v[188:191], a[112:115]
v_cvt_pk_bf16_f32 v194, v184, v185
v_add_f32 v218, v218, v186
v_mfma_f32_16x16x32_bf16 a[116:119], v[160:163], v[188:191], a[116:119]
v_cvt_pk_bf16_f32 v195, v186, v187
v_add_f32 v218, v218, v187
v_mfma_f32_16x16x32_bf16 a[120:123], v[164:167], v[188:191], a[120:123]
v_mfma_f32_16x16x32_bf16 a[124:127], v[168:171], v[188:191], a[124:127]
s_waitcnt vmcnt(20)
v_mfma_f32_16x16x32_bf16 v[180:183], v[108:111], a[240:243], v[104:107]
ds_read_b128 v[108:111], v196 offset:0
v_exp_f32 v172, v172
v_mfma_f32_16x16x32_bf16 v[180:183], v[112:115], a[244:247], v[180:183]
ds_read_b128 v[112:115], v197 offset:0
s_add_u32 m0, s51, 28672
s_add_u32 s58, s58, 4096
buffer_load_dwordx4 v212, s[32:35], s58 offen nt lds
v_exp_f32 v173, v173
v_mfma_f32_16x16x32_bf16 v[180:183], v[116:119], a[248:251], v[180:183]
ds_read_b128 v[116:119], v198 offset:0
v_exp_f32 v174, v174
v_mfma_f32_16x16x32_bf16 v[180:183], v[120:123], a[252:255], v[180:183]
ds_read_b128 v[120:123], v199 offset:0
v_exp_f32 v175, v175
v_mfma_f32_16x16x32_bf16 a[128:131], v[140:143], v[192:195], a[128:131]
v_add_f32 v219, v219, v172
v_cvt_pk_bf16_f32 v188, v172, v173
v_mfma_f32_16x16x32_bf16 a[132:135], v[144:147], v[192:195], a[132:135]
v_exp_f32 v176, v176
v_mfma_f32_16x16x32_bf16 a[136:139], v[148:151], v[192:195], a[136:139]
v_add_f32 v219, v219, v173
v_add_f32 v219, v219, v174
v_mfma_f32_16x16x32_bf16 a[140:143], v[152:155], v[192:195], a[140:143]
v_exp_f32 v177, v177
v_mfma_f32_16x16x32_bf16 v[184:187], v[124:127], a[240:243], v[104:107]
ds_read_b128 v[124:127], v196 offset:4096
v_add_f32 v219, v219, v175
v_cvt_pk_bf16_f32 v189, v174, v175
v_mfma_f32_16x16x32_bf16 v[184:187], v[128:131], a[244:247], v[184:187]
ds_read_b128 v[128:131], v197 offset:4096
buffer_load_dwordx4 v213, s[32:35], s58 offen offset:1024 nt lds
v_exp_f32 v178, v178
v_mfma_f32_16x16x32_bf16 v[184:187], v[132:135], a[248:251], v[184:187]
ds_read_b128 v[132:135], v198 offset:4096
v_add_f32 v219, v219, v176
v_add_f32 v219, v219, v177
v_mfma_f32_16x16x32_bf16 v[184:187], v[136:139], a[252:255], v[184:187]
ds_read_b128 v[136:139], v199 offset:4096
v_exp_f32 v179, v179
v_mfma_f32_16x16x32_bf16 a[144:147], v[156:159], v[192:195], a[144:147]
v_cvt_pk_bf16_f32 v190, v176, v177
v_add_f32 v219, v219, v178
v_mfma_f32_16x16x32_bf16 a[148:151], v[160:163], v[192:195], a[148:151]
v_cvt_pk_bf16_f32 v191, v178, v179
v_add_f32 v219, v219, v179
v_mfma_f32_16x16x32_bf16 a[152:155], v[164:167], v[192:195], a[152:155]
v_mfma_f32_16x16x32_bf16 a[156:159], v[168:171], v[192:195], a[156:159]
s_waitcnt lgkmcnt(4)
v_mfma_f32_16x16x32_bf16 v[172:175], v[108:111], v[0:3], v[80:83]
v_exp_f32 v180, v180
v_mfma_f32_16x16x32_bf16 v[172:175], v[112:115], v[4:7], v[172:175]
buffer_load_dwordx4 v212, s[32:35], s58 offen offset:2048 nt lds
v_exp_f32 v181, v181
v_mfma_f32_16x16x32_bf16 v[172:175], v[116:119], v[8:11], v[172:175]
v_exp_f32 v182, v182
v_mfma_f32_16x16x32_bf16 v[172:175], v[120:123], v[12:15], v[172:175]
s_waitcnt lgkmcnt(0)
v_exp_f32 v183, v183
v_mfma_f32_16x16x32_bf16 a[160:163], v[140:143], v[188:191], a[160:163]
v_add_f32 v220, v220, v180
v_cvt_pk_bf16_f32 v192, v180, v181
v_mfma_f32_16x16x32_bf16 a[164:167], v[144:147], v[188:191], a[164:167]
v_exp_f32 v184, v184
v_mfma_f32_16x16x32_bf16 a[168:171], v[148:151], v[188:191], a[168:171]
v_add_f32 v220, v220, v181
v_add_f32 v220, v220, v182
v_mfma_f32_16x16x32_bf16 a[172:175], v[152:155], v[188:191], a[172:175]
v_exp_f32 v185, v185
v_mfma_f32_16x16x32_bf16 v[176:179], v[124:127], v[0:3], v[80:83]
v_add_f32 v220, v220, v183
v_cvt_pk_bf16_f32 v193, v182, v183
v_mfma_f32_16x16x32_bf16 v[176:179], v[128:131], v[4:7], v[176:179]
buffer_load_dwordx4 v213, s[32:35], s58 offen offset:3072 nt lds
v_exp_f32 v186, v186
v_mfma_f32_16x16x32_bf16 v[176:179], v[132:135], v[8:11], v[176:179]
v_add_f32 v220, v220, v184
v_add_f32 v220, v220, v185
v_mfma_f32_16x16x32_bf16 v[176:179], v[136:139], v[12:15], v[176:179]
v_exp_f32 v187, v187
v_mfma_f32_16x16x32_bf16 a[176:179], v[156:159], v[188:191], a[176:179]
v_cvt_pk_bf16_f32 v194, v184, v185
v_add_f32 v220, v220, v186
v_mfma_f32_16x16x32_bf16 a[180:183], v[160:163], v[188:191], a[180:183]
v_cvt_pk_bf16_f32 v195, v186, v187
v_add_f32 v220, v220, v187
v_mfma_f32_16x16x32_bf16 a[184:187], v[164:167], v[188:191], a[184:187]
v_mfma_f32_16x16x32_bf16 a[188:191], v[168:171], v[188:191], a[188:191]
s_waitcnt vmcnt(16)
v_mfma_f32_16x16x32_bf16 v[180:183], v[108:111], v[16:19], v[84:87]
v_exp_f32 v172, v172
v_mfma_f32_16x16x32_bf16 v[180:183], v[112:115], v[20:23], v[180:183]
s_add_u32 m0, s51, 0
s_add_u32 s58, s56, 131072
s_add_u32 s58, s58, s57
buffer_load_dwordx4 v208, s[28:31], s58 offen nt lds
v_exp_f32 v173, v173
v_mfma_f32_16x16x32_bf16 v[180:183], v[116:119], v[24:27], v[180:183]
v_exp_f32 v174, v174
v_mfma_f32_16x16x32_bf16 v[180:183], v[120:123], v[28:31], v[180:183]
v_exp_f32 v175, v175
v_mfma_f32_16x16x32_bf16 a[192:195], v[140:143], v[192:195], a[192:195]
ds_read_b64_tr_b16 v[140:141], v200 offset:0
ds_read_b64_tr_b16 v[142:143], v200 offset:4096
v_add_f32 v214, v214, v172
v_cvt_pk_bf16_f32 v188, v172, v173
v_mfma_f32_16x16x32_bf16 a[196:199], v[144:147], v[192:195], a[196:199]
ds_read_b64_tr_b16 v[144:145], v201 offset:0
ds_read_b64_tr_b16 v[146:147], v201 offset:4096
v_exp_f32 v176, v176
v_mfma_f32_16x16x32_bf16 a[200:203], v[148:151], v[192:195], a[200:203]
ds_read_b64_tr_b16 v[148:149], v202 offset:0
ds_read_b64_tr_b16 v[150:151], v202 offset:4096
buffer_load_dwordx4 v209, s[28:31], s58 offen offset:1024 nt lds
v_add_f32 v214, v214, v173
v_add_f32 v214, v214, v174
v_mfma_f32_16x16x32_bf16 a[204:207], v[152:155], v[192:195], a[204:207]
ds_read_b64_tr_b16 v[152:153], v203 offset:0
ds_read_b64_tr_b16 v[154:155], v203 offset:4096
v_exp_f32 v177, v177
v_mfma_f32_16x16x32_bf16 v[184:187], v[124:127], v[16:19], v[84:87]
v_add_f32 v214, v214, v175
v_cvt_pk_bf16_f32 v189, v174, v175
v_mfma_f32_16x16x32_bf16 v[184:187], v[128:131], v[20:23], v[184:187]
v_exp_f32 v178, v178
v_mfma_f32_16x16x32_bf16 v[184:187], v[132:135], v[24:27], v[184:187]
v_add_f32 v214, v214, v176
v_add_f32 v214, v214, v177
v_mfma_f32_16x16x32_bf16 v[184:187], v[136:139], v[28:31], v[184:187]
buffer_load_dwordx4 v210, s[28:31], s58 offen offset:2048 nt lds
v_exp_f32 v179, v179
v_mfma_f32_16x16x32_bf16 a[208:211], v[156:159], v[192:195], a[208:211]
ds_read_b64_tr_b16 v[156:157], v204 offset:0
ds_read_b64_tr_b16 v[158:159], v204 offset:4096
v_cvt_pk_bf16_f32 v190, v176, v177
v_add_f32 v214, v214, v178
v_mfma_f32_16x16x32_bf16 a[212:215], v[160:163], v[192:195], a[212:215]
ds_read_b64_tr_b16 v[160:161], v205 offset:0
ds_read_b64_tr_b16 v[162:163], v205 offset:4096
v_cvt_pk_bf16_f32 v191, v178, v179
v_add_f32 v214, v214, v179
v_mfma_f32_16x16x32_bf16 a[216:219], v[164:167], v[192:195], a[216:219]
ds_read_b64_tr_b16 v[164:165], v206 offset:0
ds_read_b64_tr_b16 v[166:167], v206 offset:4096
v_mfma_f32_16x16x32_bf16 a[220:223], v[168:171], v[192:195], a[220:223]
ds_read_b64_tr_b16 v[168:169], v207 offset:0
ds_read_b64_tr_b16 v[170:171], v207 offset:4096
s_waitcnt lgkmcnt(8)
v_mfma_f32_16x16x32_bf16 v[172:175], v[108:111], v[32:35], v[88:91]
v_exp_f32 v180, v180
v_mfma_f32_16x16x32_bf16 v[172:175], v[112:115], v[36:39], v[172:175]
buffer_load_dwordx4 v211, s[28:31], s58 offen offset:3072 nt lds
v_exp_f32 v181, v181
v_mfma_f32_16x16x32_bf16 v[172:175], v[116:119], v[40:43], v[172:175]
v_exp_f32 v182, v182
v_mfma_f32_16x16x32_bf16 v[172:175], v[120:123], v[44:47], v[172:175]
v_exp_f32 v183, v183
v_mfma_f32_16x16x32_bf16 a[0:3], v[140:143], v[188:191], a[0:3]
v_add_f32 v215, v215, v180
v_cvt_pk_bf16_f32 v192, v180, v181
v_mfma_f32_16x16x32_bf16 a[4:7], v[144:147], v[188:191], a[4:7]
v_exp_f32 v184, v184
v_mfma_f32_16x16x32_bf16 a[8:11], v[148:151], v[188:191], a[8:11]
s_add_u32 m0, s51, 4096
s_add_u32 s58, s58, 4096
buffer_load_dwordx4 v208, s[28:31], s58 offen nt lds
v_add_f32 v215, v215, v181
v_add_f32 v215, v215, v182
v_mfma_f32_16x16x32_bf16 a[12:15], v[152:155], v[188:191], a[12:15]
s_waitcnt lgkmcnt(0)
v_exp_f32 v185, v185
v_mfma_f32_16x16x32_bf16 v[176:179], v[124:127], v[32:35], v[88:91]
v_add_f32 v215, v215, v183
v_cvt_pk_bf16_f32 v193, v182, v183
v_mfma_f32_16x16x32_bf16 v[176:179], v[128:131], v[36:39], v[176:179]
v_exp_f32 v186, v186
v_mfma_f32_16x16x32_bf16 v[176:179], v[132:135], v[40:43], v[176:179]
v_add_f32 v215, v215, v184
v_add_f32 v215, v215, v185
v_mfma_f32_16x16x32_bf16 v[176:179], v[136:139], v[44:47], v[176:179]
buffer_load_dwordx4 v209, s[28:31], s58 offen offset:1024 nt lds
v_exp_f32 v187, v187
v_mfma_f32_16x16x32_bf16 a[16:19], v[156:159], v[188:191], a[16:19]
v_cvt_pk_bf16_f32 v194, v184, v185
v_add_f32 v215, v215, v186
v_mfma_f32_16x16x32_bf16 a[20:23], v[160:163], v[188:191], a[20:23]
v_cvt_pk_bf16_f32 v195, v186, v187
v_add_f32 v215, v215, v187
v_mfma_f32_16x16x32_bf16 a[24:27], v[164:167], v[188:191], a[24:27]
v_mfma_f32_16x16x32_bf16 a[28:31], v[168:171], v[188:191], a[28:31]
v_mfma_f32_16x16x32_bf16 v[180:183], v[108:111], v[48:51], v[92:95]
v_exp_f32 v172, v172
v_mfma_f32_16x16x32_bf16 v[180:183], v[112:115], v[52:55], v[180:183]
buffer_load_dwordx4 v210, s[28:31], s58 offen offset:2048 nt lds
v_exp_f32 v173, v173
v_mfma_f32_16x16x32_bf16 v[180:183], v[116:119], v[56:59], v[180:183]
v_exp_f32 v174, v174
v_mfma_f32_16x16x32_bf16 v[180:183], v[120:123], v[60:63], v[180:183]
v_exp_f32 v175, v175
v_mfma_f32_16x16x32_bf16 a[32:35], v[140:143], v[192:195], a[32:35]
v_add_f32 v216, v216, v172
v_cvt_pk_bf16_f32 v188, v172, v173
v_mfma_f32_16x16x32_bf16 a[36:39], v[144:147], v[192:195], a[36:39]
v_exp_f32 v176, v176
v_mfma_f32_16x16x32_bf16 a[40:43], v[148:151], v[192:195], a[40:43]
v_add_f32 v216, v216, v173
v_add_f32 v216, v216, v174
v_mfma_f32_16x16x32_bf16 a[44:47], v[152:155], v[192:195], a[44:47]
v_exp_f32 v177, v177
v_mfma_f32_16x16x32_bf16 v[184:187], v[124:127], v[48:51], v[92:95]
v_add_f32 v216, v216, v175
v_cvt_pk_bf16_f32 v189, v174, v175
v_mfma_f32_16x16x32_bf16 v[184:187], v[128:131], v[52:55], v[184:187]
buffer_load_dwordx4 v211, s[28:31], s58 offen offset:3072 nt lds
v_exp_f32 v178, v178
v_mfma_f32_16x16x32_bf16 v[184:187], v[132:135], v[56:59], v[184:187]
v_add_f32 v216, v216, v176
v_add_f32 v216, v216, v177
v_mfma_f32_16x16x32_bf16 v[184:187], v[136:139], v[60:63], v[184:187]
v_exp_f32 v179, v179
v_mfma_f32_16x16x32_bf16 a[48:51], v[156:159], v[192:195], a[48:51]
v_cvt_pk_bf16_f32 v190, v176, v177
v_add_f32 v216, v216, v178
v_mfma_f32_16x16x32_bf16 a[52:55], v[160:163], v[192:195], a[52:55]
v_cvt_pk_bf16_f32 v191, v178, v179
v_add_f32 v216, v216, v179
v_mfma_f32_16x16x32_bf16 a[56:59], v[164:167], v[192:195], a[56:59]
v_mfma_f32_16x16x32_bf16 a[60:63], v[168:171], v[192:195], a[60:63]
v_mfma_f32_16x16x32_bf16 v[172:175], v[108:111], v[64:67], v[96:99]
v_exp_f32 v180, v180
v_mfma_f32_16x16x32_bf16 v[172:175], v[112:115], v[68:71], v[172:175]
s_add_u32 m0, s51, 16384
s_add_u32 s58, s56, 131072
s_add_u32 s58, s58, s57
buffer_load_dwordx4 v212, s[32:35], s58 offen nt lds
v_exp_f32 v181, v181
v_mfma_f32_16x16x32_bf16 v[172:175], v[116:119], v[72:75], v[172:175]
v_exp_f32 v182, v182
v_mfma_f32_16x16x32_bf16 v[172:175], v[120:123], v[76:79], v[172:175]
v_exp_f32 v183, v183
v_mfma_f32_16x16x32_bf16 a[64:67], v[140:143], v[188:191], a[64:67]
v_add_f32 v217, v217, v180
v_cvt_pk_bf16_f32 v192, v180, v181
v_mfma_f32_16x16x32_bf16 a[68:71], v[144:147], v[188:191], a[68:71]
v_exp_f32 v184, v184
v_mfma_f32_16x16x32_bf16 a[72:75], v[148:151], v[188:191], a[72:75]
v_add_f32 v217, v217, v181
v_add_f32 v217, v217, v182
v_mfma_f32_16x16x32_bf16 a[76:79], v[152:155], v[188:191], a[76:79]
v_exp_f32 v185, v185
v_mfma_f32_16x16x32_bf16 v[176:179], v[124:127], v[64:67], v[96:99]
v_add_f32 v217, v217, v183
v_cvt_pk_bf16_f32 v193, v182, v183
v_mfma_f32_16x16x32_bf16 v[176:179], v[128:131], v[68:71], v[176:179]
buffer_load_dwordx4 v213, s[32:35], s58 offen offset:1024 nt lds
v_exp_f32 v186, v186
v_mfma_f32_16x16x32_bf16 v[176:179], v[132:135], v[72:75], v[176:179]
v_add_f32 v217, v217, v184
v_add_f32 v217, v217, v185
v_mfma_f32_16x16x32_bf16 v[176:179], v[136:139], v[76:79], v[176:179]
v_exp_f32 v187, v187
v_mfma_f32_16x16x32_bf16 a[80:83], v[156:159], v[188:191], a[80:83]
v_cvt_pk_bf16_f32 v194, v184, v185
v_add_f32 v217, v217, v186
v_mfma_f32_16x16x32_bf16 a[84:87], v[160:163], v[188:191], a[84:87]
v_cvt_pk_bf16_f32 v195, v186, v187
v_add_f32 v217, v217, v187
v_mfma_f32_16x16x32_bf16 a[88:91], v[164:167], v[188:191], a[88:91]
v_mfma_f32_16x16x32_bf16 a[92:95], v[168:171], v[188:191], a[92:95]
v_mfma_f32_16x16x32_bf16 v[180:183], v[108:111], a[224:227], v[100:103]
v_exp_f32 v172, v172
v_mfma_f32_16x16x32_bf16 v[180:183], v[112:115], a[228:231], v[180:183]
buffer_load_dwordx4 v212, s[32:35], s58 offen offset:2048 nt lds
v_exp_f32 v173, v173
v_mfma_f32_16x16x32_bf16 v[180:183], v[116:119], a[232:235], v[180:183]
v_exp_f32 v174, v174
v_mfma_f32_16x16x32_bf16 v[180:183], v[120:123], a[236:239], v[180:183]
v_exp_f32 v175, v175
v_mfma_f32_16x16x32_bf16 a[96:99], v[140:143], v[192:195], a[96:99]
v_add_f32 v218, v218, v172
v_cvt_pk_bf16_f32 v188, v172, v173
v_mfma_f32_16x16x32_bf16 a[100:103], v[144:147], v[192:195], a[100:103]
v_exp_f32 v176, v176
v_mfma_f32_16x16x32_bf16 a[104:107], v[148:151], v[192:195], a[104:107]
v_add_f32 v218, v218, v173
v_add_f32 v218, v218, v174
v_mfma_f32_16x16x32_bf16 a[108:111], v[152:155], v[192:195], a[108:111]
v_exp_f32 v177, v177
v_mfma_f32_16x16x32_bf16 v[184:187], v[124:127], a[224:227], v[100:103]
v_add_f32 v218, v218, v175
v_cvt_pk_bf16_f32 v189, v174, v175
v_mfma_f32_16x16x32_bf16 v[184:187], v[128:131], a[228:231], v[184:187]
buffer_load_dwordx4 v213, s[32:35], s58 offen offset:3072 nt lds
v_exp_f32 v178, v178
v_mfma_f32_16x16x32_bf16 v[184:187], v[132:135], a[232:235], v[184:187]
v_add_f32 v218, v218, v176
v_add_f32 v218, v218, v177
v_mfma_f32_16x16x32_bf16 v[184:187], v[136:139], a[236:239], v[184:187]
v_exp_f32 v179, v179
v_mfma_f32_16x16x32_bf16 a[112:115], v[156:159], v[192:195], a[112:115]
v_cvt_pk_bf16_f32 v190, v176, v177
v_add_f32 v218, v218, v178
v_mfma_f32_16x16x32_bf16 a[116:119], v[160:163], v[192:195], a[116:119]
v_cvt_pk_bf16_f32 v191, v178, v179
v_add_f32 v218, v218, v179
v_mfma_f32_16x16x32_bf16 a[120:123], v[164:167], v[192:195], a[120:123]
v_mfma_f32_16x16x32_bf16 a[124:127], v[168:171], v[192:195], a[124:127]
s_waitcnt vmcnt(20)
v_mfma_f32_16x16x32_bf16 v[172:175], v[108:111], a[240:243], v[104:107]
ds_read_b128 v[108:111], v196 offset:8192
v_exp_f32 v180, v180
v_mfma_f32_16x16x32_bf16 v[172:175], v[112:115], a[244:247], v[172:175]
ds_read_b128 v[112:115], v197 offset:8192
s_add_u32 m0, s51, 20480
s_add_u32 s58, s58, 4096
buffer_load_dwordx4 v212, s[32:35], s58 offen nt lds
v_exp_f32 v181, v181
v_mfma_f32_16x16x32_bf16 v[172:175], v[116:119], a[248:251], v[172:175]
ds_read_b128 v[116:119], v198 offset:8192
v_exp_f32 v182, v182
v_mfma_f32_16x16x32_bf16 v[172:175], v[120:123], a[252:255], v[172:175]
ds_read_b128 v[120:123], v199 offset:8192
v_exp_f32 v183, v183
v_mfma_f32_16x16x32_bf16 a[128:131], v[140:143], v[188:191], a[128:131]
v_add_f32 v219, v219, v180
v_cvt_pk_bf16_f32 v192, v180, v181
v_mfma_f32_16x16x32_bf16 a[132:135], v[144:147], v[188:191], a[132:135]
v_exp_f32 v184, v184
v_mfma_f32_16x16x32_bf16 a[136:139], v[148:151], v[188:191], a[136:139]
v_add_f32 v219, v219, v181
v_add_f32 v219, v219, v182
v_mfma_f32_16x16x32_bf16 a[140:143], v[152:155], v[188:191], a[140:143]
v_exp_f32 v185, v185
v_mfma_f32_16x16x32_bf16 v[176:179], v[124:127], a[240:243], v[104:107]
ds_read_b128 v[124:127], v196 offset:12288
v_add_f32 v219, v219, v183
v_cvt_pk_bf16_f32 v193, v182, v183
v_mfma_f32_16x16x32_bf16 v[176:179], v[128:131], a[244:247], v[176:179]
ds_read_b128 v[128:131], v197 offset:12288
buffer_load_dwordx4 v213, s[32:35], s58 offen offset:1024 nt lds
v_exp_f32 v186, v186
v_mfma_f32_16x16x32_bf16 v[176:179], v[132:135], a[248:251], v[176:179]
ds_read_b128 v[132:135], v198 offset:12288
v_add_f32 v219, v219, v184
v_add_f32 v219, v219, v185
v_mfma_f32_16x16x32_bf16 v[176:179], v[136:139], a[252:255], v[176:179]
ds_read_b128 v[136:139], v199 offset:12288
v_exp_f32 v187, v187
v_mfma_f32_16x16x32_bf16 a[144:147], v[156:159], v[188:191], a[144:147]
v_cvt_pk_bf16_f32 v194, v184, v185
v_add_f32 v219, v219, v186
v_mfma_f32_16x16x32_bf16 a[148:151], v[160:163], v[188:191], a[148:151]
v_cvt_pk_bf16_f32 v195, v186, v187
v_add_f32 v219, v219, v187
v_mfma_f32_16x16x32_bf16 a[152:155], v[164:167], v[188:191], a[152:155]
v_mfma_f32_16x16x32_bf16 a[156:159], v[168:171], v[188:191], a[156:159]
s_waitcnt lgkmcnt(4)
v_mfma_f32_16x16x32_bf16 v[180:183], v[108:111], v[0:3], v[80:83]
v_exp_f32 v172, v172
v_mfma_f32_16x16x32_bf16 v[180:183], v[112:115], v[4:7], v[180:183]
buffer_load_dwordx4 v212, s[32:35], s58 offen offset:2048 nt lds
v_exp_f32 v173, v173
v_mfma_f32_16x16x32_bf16 v[180:183], v[116:119], v[8:11], v[180:183]
v_exp_f32 v174, v174
v_mfma_f32_16x16x32_bf16 v[180:183], v[120:123], v[12:15], v[180:183]
s_waitcnt lgkmcnt(0)
v_exp_f32 v175, v175
v_mfma_f32_16x16x32_bf16 a[160:163], v[140:143], v[192:195], a[160:163]
v_add_f32 v220, v220, v172
v_cvt_pk_bf16_f32 v188, v172, v173
v_mfma_f32_16x16x32_bf16 a[164:167], v[144:147], v[192:195], a[164:167]
v_exp_f32 v176, v176
v_mfma_f32_16x16x32_bf16 a[168:171], v[148:151], v[192:195], a[168:171]
v_add_f32 v220, v220, v173
v_add_f32 v220, v220, v174
v_mfma_f32_16x16x32_bf16 a[172:175], v[152:155], v[192:195], a[172:175]
v_exp_f32 v177, v177
v_mfma_f32_16x16x32_bf16 v[184:187], v[124:127], v[0:3], v[80:83]
v_add_f32 v220, v220, v175
v_cvt_pk_bf16_f32 v189, v174, v175
v_mfma_f32_16x16x32_bf16 v[184:187], v[128:131], v[4:7], v[184:187]
buffer_load_dwordx4 v213, s[32:35], s58 offen offset:3072 nt lds
v_exp_f32 v178, v178
v_mfma_f32_16x16x32_bf16 v[184:187], v[132:135], v[8:11], v[184:187]
v_add_f32 v220, v220, v176
v_add_f32 v220, v220, v177
v_mfma_f32_16x16x32_bf16 v[184:187], v[136:139], v[12:15], v[184:187]
v_exp_f32 v179, v179
v_mfma_f32_16x16x32_bf16 a[176:179], v[156:159], v[192:195], a[176:179]
v_cvt_pk_bf16_f32 v190, v176, v177
v_add_f32 v220, v220, v178
v_mfma_f32_16x16x32_bf16 a[180:183], v[160:163], v[192:195], a[180:183]
v_cvt_pk_bf16_f32 v191, v178, v179
v_add_f32 v220, v220, v179
v_mfma_f32_16x16x32_bf16 a[184:187], v[164:167], v[192:195], a[184:187]
v_mfma_f32_16x16x32_bf16 a[188:191], v[168:171], v[192:195], a[188:191]
s_waitcnt vmcnt(16)
v_mfma_f32_16x16x32_bf16 v[172:175], v[108:111], v[16:19], v[84:87]
v_exp_f32 v180, v180
v_mfma_f32_16x16x32_bf16 v[172:175], v[112:115], v[20:23], v[172:175]
s_add_u32 m0, s51, 8192
s_add_u32 s58, s56, 163840
s_sub_u32 s58, s58, s57
buffer_load_dwordx4 v208, s[28:31], s58 offen nt lds
v_exp_f32 v181, v181
v_mfma_f32_16x16x32_bf16 v[172:175], v[116:119], v[24:27], v[172:175]
v_exp_f32 v182, v182
v_mfma_f32_16x16x32_bf16 v[172:175], v[120:123], v[28:31], v[172:175]
v_exp_f32 v183, v183
v_mfma_f32_16x16x32_bf16 a[192:195], v[140:143], v[188:191], a[192:195]
ds_read_b64_tr_b16 v[140:141], v200 offset:8192
ds_read_b64_tr_b16 v[142:143], v200 offset:12288
v_add_f32 v214, v214, v180
v_cvt_pk_bf16_f32 v192, v180, v181
v_mfma_f32_16x16x32_bf16 a[196:199], v[144:147], v[188:191], a[196:199]
ds_read_b64_tr_b16 v[144:145], v201 offset:8192
ds_read_b64_tr_b16 v[146:147], v201 offset:12288
v_exp_f32 v184, v184
v_mfma_f32_16x16x32_bf16 a[200:203], v[148:151], v[188:191], a[200:203]
ds_read_b64_tr_b16 v[148:149], v202 offset:8192
ds_read_b64_tr_b16 v[150:151], v202 offset:12288
buffer_load_dwordx4 v209, s[28:31], s58 offen offset:1024 nt lds
v_add_f32 v214, v214, v181
v_add_f32 v214, v214, v182
v_mfma_f32_16x16x32_bf16 a[204:207], v[152:155], v[188:191], a[204:207]
ds_read_b64_tr_b16 v[152:153], v203 offset:8192
ds_read_b64_tr_b16 v[154:155], v203 offset:12288
v_exp_f32 v185, v185
v_mfma_f32_16x16x32_bf16 v[176:179], v[124:127], v[16:19], v[84:87]
v_add_f32 v214, v214, v183
v_cvt_pk_bf16_f32 v193, v182, v183
v_mfma_f32_16x16x32_bf16 v[176:179], v[128:131], v[20:23], v[176:179]
v_exp_f32 v186, v186
v_mfma_f32_16x16x32_bf16 v[176:179], v[132:135], v[24:27], v[176:179]
v_add_f32 v214, v214, v184
v_add_f32 v214, v214, v185
v_mfma_f32_16x16x32_bf16 v[176:179], v[136:139], v[28:31], v[176:179]
buffer_load_dwordx4 v210, s[28:31], s58 offen offset:2048 nt lds
v_exp_f32 v187, v187
v_mfma_f32_16x16x32_bf16 a[208:211], v[156:159], v[188:191], a[208:211]
ds_read_b64_tr_b16 v[156:157], v204 offset:8192
ds_read_b64_tr_b16 v[158:159], v204 offset:12288
v_cvt_pk_bf16_f32 v194, v184, v185
v_add_f32 v214, v214, v186
v_mfma_f32_16x16x32_bf16 a[212:215], v[160:163], v[188:191], a[212:215]
ds_read_b64_tr_b16 v[160:161], v205 offset:8192
ds_read_b64_tr_b16 v[162:163], v205 offset:12288
v_cvt_pk_bf16_f32 v195, v186, v187
v_add_f32 v214, v214, v187
v_mfma_f32_16x16x32_bf16 a[216:219], v[164:167], v[188:191], a[216:219]
ds_read_b64_tr_b16 v[164:165], v206 offset:8192
ds_read_b64_tr_b16 v[166:167], v206 offset:12288
v_mfma_f32_16x16x32_bf16 a[220:223], v[168:171], v[188:191], a[220:223]
ds_read_b64_tr_b16 v[168:169], v207 offset:8192
ds_read_b64_tr_b16 v[170:171], v207 offset:12288
s_waitcnt lgkmcnt(8)
v_mfma_f32_16x16x32_bf16 v[180:183], v[108:111], v[32:35], v[88:91]
v_exp_f32 v172, v172
v_mfma_f32_16x16x32_bf16 v[180:183], v[112:115], v[36:39], v[180:183]
buffer_load_dwordx4 v211, s[28:31], s58 offen offset:3072 nt lds
v_exp_f32 v173, v173
v_mfma_f32_16x16x32_bf16 v[180:183], v[116:119], v[40:43], v[180:183]
v_exp_f32 v174, v174
v_mfma_f32_16x16x32_bf16 v[180:183], v[120:123], v[44:47], v[180:183]
v_exp_f32 v175, v175
v_mfma_f32_16x16x32_bf16 a[0:3], v[140:143], v[192:195], a[0:3]
v_add_f32 v215, v215, v172
v_cvt_pk_bf16_f32 v188, v172, v173
v_mfma_f32_16x16x32_bf16 a[4:7], v[144:147], v[192:195], a[4:7]
v_exp_f32 v176, v176
v_mfma_f32_16x16x32_bf16 a[8:11], v[148:151], v[192:195], a[8:11]
s_add_u32 m0, s51, 12288
s_add_u32 s58, s58, 4096
buffer_load_dwordx4 v208, s[28:31], s58 offen nt lds
v_add_f32 v215, v215, v173
v_add_f32 v215, v215, v174
v_mfma_f32_16x16x32_bf16 a[12:15], v[152:155], v[192:195], a[12:15]
s_waitcnt lgkmcnt(0)
v_exp_f32 v177, v177
v_mfma_f32_16x16x32_bf16 v[184:187], v[124:127], v[32:35], v[88:91]
v_add_f32 v215, v215, v175
v_cvt_pk_bf16_f32 v189, v174, v175
v_mfma_f32_16x16x32_bf16 v[184:187], v[128:131], v[36:39], v[184:187]
v_exp_f32 v178, v178
v_mfma_f32_16x16x32_bf16 v[184:187], v[132:135], v[40:43], v[184:187]
v_add_f32 v215, v215, v176
v_add_f32 v215, v215, v177
v_mfma_f32_16x16x32_bf16 v[184:187], v[136:139], v[44:47], v[184:187]
buffer_load_dwordx4 v209, s[28:31], s58 offen offset:1024 nt lds
v_exp_f32 v179, v179
v_mfma_f32_16x16x32_bf16 a[16:19], v[156:159], v[192:195], a[16:19]
v_cvt_pk_bf16_f32 v190, v176, v177
v_add_f32 v215, v215, v178
v_mfma_f32_16x16x32_bf16 a[20:23], v[160:163], v[192:195], a[20:23]
v_cvt_pk_bf16_f32 v191, v178, v179
v_add_f32 v215, v215, v179
v_mfma_f32_16x16x32_bf16 a[24:27], v[164:167], v[192:195], a[24:27]
v_mfma_f32_16x16x32_bf16 a[28:31], v[168:171], v[192:195], a[28:31]
v_mfma_f32_16x16x32_bf16 v[172:175], v[108:111], v[48:51], v[92:95]
v_exp_f32 v180, v180
v_mfma_f32_16x16x32_bf16 v[172:175], v[112:115], v[52:55], v[172:175]
buffer_load_dwordx4 v210, s[28:31], s58 offen offset:2048 nt lds
v_exp_f32 v181, v181
v_mfma_f32_16x16x32_bf16 v[172:175], v[116:119], v[56:59], v[172:175]
v_exp_f32 v182, v182
v_mfma_f32_16x16x32_bf16 v[172:175], v[120:123], v[60:63], v[172:175]
v_exp_f32 v183, v183
v_mfma_f32_16x16x32_bf16 a[32:35], v[140:143], v[188:191], a[32:35]
v_add_f32 v216, v216, v180
v_cvt_pk_bf16_f32 v192, v180, v181
v_mfma_f32_16x16x32_bf16 a[36:39], v[144:147], v[188:191], a[36:39]
v_exp_f32 v184, v184
v_mfma_f32_16x16x32_bf16 a[40:43], v[148:151], v[188:191], a[40:43]
v_add_f32 v216, v216, v181
v_add_f32 v216, v216, v182
v_mfma_f32_16x16x32_bf16 a[44:47], v[152:155], v[188:191], a[44:47]
v_exp_f32 v185, v185
v_mfma_f32_16x16x32_bf16 v[176:179], v[124:127], v[48:51], v[92:95]
v_add_f32 v216, v216, v183
v_cvt_pk_bf16_f32 v193, v182, v183
v_mfma_f32_16x16x32_bf16 v[176:179], v[128:131], v[52:55], v[176:179]
buffer_load_dwordx4 v211, s[28:31], s58 offen offset:3072 nt lds
v_exp_f32 v186, v186
v_mfma_f32_16x16x32_bf16 v[176:179], v[132:135], v[56:59], v[176:179]
v_add_f32 v216, v216, v184
v_add_f32 v216, v216, v185
v_mfma_f32_16x16x32_bf16 v[176:179], v[136:139], v[60:63], v[176:179]
v_exp_f32 v187, v187
v_mfma_f32_16x16x32_bf16 a[48:51], v[156:159], v[188:191], a[48:51]
v_cvt_pk_bf16_f32 v194, v184, v185
v_add_f32 v216, v216, v186
v_mfma_f32_16x16x32_bf16 a[52:55], v[160:163], v[188:191], a[52:55]
v_cvt_pk_bf16_f32 v195, v186, v187
v_add_f32 v216, v216, v187
v_mfma_f32_16x16x32_bf16 a[56:59], v[164:167], v[188:191], a[56:59]
v_mfma_f32_16x16x32_bf16 a[60:63], v[168:171], v[188:191], a[60:63]
v_mfma_f32_16x16x32_bf16 v[180:183], v[108:111], v[64:67], v[96:99]
v_exp_f32 v172, v172
v_mfma_f32_16x16x32_bf16 v[180:183], v[112:115], v[68:71], v[180:183]
s_add_u32 m0, s51, 24576
s_add_u32 s58, s56, 163840
s_sub_u32 s58, s58, s57
buffer_load_dwordx4 v212, s[32:35], s58 offen nt lds
v_exp_f32 v173, v173
v_mfma_f32_16x16x32_bf16 v[180:183], v[116:119], v[72:75], v[180:183]
v_exp_f32 v174, v174
v_mfma_f32_16x16x32_bf16 v[180:183], v[120:123], v[76:79], v[180:183]
v_exp_f32 v175, v175
v_mfma_f32_16x16x32_bf16 a[64:67], v[140:143], v[192:195], a[64:67]
v_add_f32 v217, v217, v172
v_cvt_pk_bf16_f32 v188, v172, v173
v_mfma_f32_16x16x32_bf16 a[68:71], v[144:147], v[192:195], a[68:71]
v_exp_f32 v176, v176
v_mfma_f32_16x16x32_bf16 a[72:75], v[148:151], v[192:195], a[72:75]
v_add_f32 v217, v217, v173
v_add_f32 v217, v217, v174
v_mfma_f32_16x16x32_bf16 a[76:79], v[152:155], v[192:195], a[76:79]
v_exp_f32 v177, v177
v_mfma_f32_16x16x32_bf16 v[184:187], v[124:127], v[64:67], v[96:99]
v_add_f32 v217, v217, v175
v_cvt_pk_bf16_f32 v189, v174, v175
v_mfma_f32_16x16x32_bf16 v[184:187], v[128:131], v[68:71], v[184:187]
buffer_load_dwordx4 v213, s[32:35], s58 offen offset:1024 nt lds
v_exp_f32 v178, v178
v_mfma_f32_16x16x32_bf16 v[184:187], v[132:135], v[72:75], v[184:187]
v_add_f32 v217, v217, v176
v_add_f32 v217, v217, v177
v_mfma_f32_16x16x32_bf16 v[184:187], v[136:139], v[76:79], v[184:187]
v_exp_f32 v179, v179
v_mfma_f32_16x16x32_bf16 a[80:83], v[156:159], v[192:195], a[80:83]
v_cvt_pk_bf16_f32 v190, v176, v177
v_add_f32 v217, v217, v178
v_mfma_f32_16x16x32_bf16 a[84:87], v[160:163], v[192:195], a[84:87]
v_cvt_pk_bf16_f32 v191, v178, v179
v_add_f32 v217, v217, v179
v_mfma_f32_16x16x32_bf16 a[88:91], v[164:167], v[192:195], a[88:91]
v_mfma_f32_16x16x32_bf16 a[92:95], v[168:171], v[192:195], a[92:95]
v_mfma_f32_16x16x32_bf16 v[172:175], v[108:111], a[224:227], v[100:103]
v_exp_f32 v180, v180
v_mfma_f32_16x16x32_bf16 v[172:175], v[112:115], a[228:231], v[172:175]
buffer_load_dwordx4 v212, s[32:35], s58 offen offset:2048 nt lds
v_exp_f32 v181, v181
v_mfma_f32_16x16x32_bf16 v[172:175], v[116:119], a[232:235], v[172:175]
v_exp_f32 v182, v182
v_mfma_f32_16x16x32_bf16 v[172:175], v[120:123], a[236:239], v[172:175]
v_exp_f32 v183, v183
v_mfma_f32_16x16x32_bf16 a[96:99], v[140:143], v[188:191], a[96:99]
v_add_f32 v218, v218, v180
v_cvt_pk_bf16_f32 v192, v180, v181
v_mfma_f32_16x16x32_bf16 a[100:103], v[144:147], v[188:191], a[100:103]
v_exp_f32 v184, v184
v_mfma_f32_16x16x32_bf16 a[104:107], v[148:151], v[188:191], a[104:107]
v_add_f32 v218, v218, v181
v_add_f32 v218, v218, v182
v_mfma_f32_16x16x32_bf16 a[108:111], v[152:155], v[188:191], a[108:111]
v_exp_f32 v185, v185
v_mfma_f32_16x16x32_bf16 v[176:179], v[124:127], a[224:227], v[100:103]
v_add_f32 v218, v218, v183
v_cvt_pk_bf16_f32 v193, v182, v183
v_mfma_f32_16x16x32_bf16 v[176:179], v[128:131], a[228:231], v[176:179]
buffer_load_dwordx4 v213, s[32:35], s58 offen offset:3072 nt lds
v_exp_f32 v186, v186
v_mfma_f32_16x16x32_bf16 v[176:179], v[132:135], a[232:235], v[176:179]
v_add_f32 v218, v218, v184
v_add_f32 v218, v218, v185
v_mfma_f32_16x16x32_bf16 v[176:179], v[136:139], a[236:239], v[176:179]
v_exp_f32 v187, v187
v_mfma_f32_16x16x32_bf16 a[112:115], v[156:159], v[188:191], a[112:115]
v_cvt_pk_bf16_f32 v194, v184, v185
v_add_f32 v218, v218, v186
v_mfma_f32_16x16x32_bf16 a[116:119], v[160:163], v[188:191], a[116:119]
v_cvt_pk_bf16_f32 v195, v186, v187
v_add_f32 v218, v218, v187
v_mfma_f32_16x16x32_bf16 a[120:123], v[164:167], v[188:191], a[120:123]
v_mfma_f32_16x16x32_bf16 a[124:127], v[168:171], v[188:191], a[124:127]
s_waitcnt vmcnt(20)
v_mfma_f32_16x16x32_bf16 v[180:183], v[108:111], a[240:243], v[104:107]
ds_read_b128 v[108:111], v196 offset:0
v_exp_f32 v172, v172
v_mfma_f32_16x16x32_bf16 v[180:183], v[112:115], a[244:247], v[180:183]
ds_read_b128 v[112:115], v197 offset:0
s_add_u32 m0, s51, 28672
s_add_u32 s58, s58, 4096
buffer_load_dwordx4 v212, s[32:35], s58 offen nt lds
v_exp_f32 v173, v173
v_mfma_f32_16x16x32_bf16 v[180:183], v[116:119], a[248:251], v[180:183]
ds_read_b128 v[116:119], v198 offset:0
v_exp_f32 v174, v174
v_mfma_f32_16x16x32_bf16 v[180:183], v[120:123], a[252:255], v[180:183]
ds_read_b128 v[120:123], v199 offset:0
v_exp_f32 v175, v175
v_mfma_f32_16x16x32_bf16 a[128:131], v[140:143], v[192:195], a[128:131]
v_add_f32 v219, v219, v172
v_cvt_pk_bf16_f32 v188, v172, v173
v_mfma_f32_16x16x32_bf16 a[132:135], v[144:147], v[192:195], a[132:135]
v_exp_f32 v176, v176
v_mfma_f32_16x16x32_bf16 a[136:139], v[148:151], v[192:195], a[136:139]
v_add_f32 v219, v219, v173
v_add_f32 v219, v219, v174
v_mfma_f32_16x16x32_bf16 a[140:143], v[152:155], v[192:195], a[140:143]
v_exp_f32 v177, v177
v_mfma_f32_16x16x32_bf16 v[184:187], v[124:127], a[240:243], v[104:107]
ds_read_b128 v[124:127], v196 offset:4096
v_add_f32 v219, v219, v175
v_cvt_pk_bf16_f32 v189, v174, v175
v_mfma_f32_16x16x32_bf16 v[184:187], v[128:131], a[244:247], v[184:187]
ds_read_b128 v[128:131], v197 offset:4096
buffer_load_dwordx4 v213, s[32:35], s58 offen offset:1024 nt lds
v_exp_f32 v178, v178
v_mfma_f32_16x16x32_bf16 v[184:187], v[132:135], a[248:251], v[184:187]
ds_read_b128 v[132:135], v198 offset:4096
v_add_f32 v219, v219, v176
v_add_f32 v219, v219, v177
v_mfma_f32_16x16x32_bf16 v[184:187], v[136:139], a[252:255], v[184:187]
ds_read_b128 v[136:139], v199 offset:4096
v_exp_f32 v179, v179
v_mfma_f32_16x16x32_bf16 a[144:147], v[156:159], v[192:195], a[144:147]
v_cvt_pk_bf16_f32 v190, v176, v177
v_add_f32 v219, v219, v178
v_mfma_f32_16x16x32_bf16 a[148:151], v[160:163], v[192:195], a[148:151]
v_cvt_pk_bf16_f32 v191, v178, v179
v_add_f32 v219, v219, v179
v_mfma_f32_16x16x32_bf16 a[152:155], v[164:167], v[192:195], a[152:155]
v_mfma_f32_16x16x32_bf16 a[156:159], v[168:171], v[192:195], a[156:159]
s_waitcnt lgkmcnt(4)
v_mfma_f32_16x16x32_bf16 v[172:175], v[108:111], v[0:3], v[80:83]
v_exp_f32 v180, v180
v_mfma_f32_16x16x32_bf16 v[172:175], v[112:115], v[4:7], v[172:175]
buffer_load_dwordx4 v212, s[32:35], s58 offen offset:2048 nt lds
v_exp_f32 v181, v181
v_mfma_f32_16x16x32_bf16 v[172:175], v[116:119], v[8:11], v[172:175]
v_exp_f32 v182, v182
v_mfma_f32_16x16x32_bf16 v[172:175], v[120:123], v[12:15], v[172:175]
s_waitcnt lgkmcnt(0)
v_exp_f32 v183, v183
v_mfma_f32_16x16x32_bf16 a[160:163], v[140:143], v[188:191], a[160:163]
v_add_f32 v220, v220, v180
v_cvt_pk_bf16_f32 v192, v180, v181
v_mfma_f32_16x16x32_bf16 a[164:167], v[144:147], v[188:191], a[164:167]
v_exp_f32 v184, v184
v_mfma_f32_16x16x32_bf16 a[168:171], v[148:151], v[188:191], a[168:171]
v_add_f32 v220, v220, v181
v_add_f32 v220, v220, v182
v_mfma_f32_16x16x32_bf16 a[172:175], v[152:155], v[188:191], a[172:175]
v_exp_f32 v185, v185
v_mfma_f32_16x16x32_bf16 v[176:179], v[124:127], v[0:3], v[80:83]
v_add_f32 v220, v220, v183
v_cvt_pk_bf16_f32 v193, v182, v183
v_mfma_f32_16x16x32_bf16 v[176:179], v[128:131], v[4:7], v[176:179]
buffer_load_dwordx4 v213, s[32:35], s58 offen offset:3072 nt lds
v_exp_f32 v186, v186
v_mfma_f32_16x16x32_bf16 v[176:179], v[132:135], v[8:11], v[176:179]
v_add_f32 v220, v220, v184
v_add_f32 v220, v220, v185
v_mfma_f32_16x16x32_bf16 v[176:179], v[136:139], v[12:15], v[176:179]
v_exp_f32 v187, v187
v_mfma_f32_16x16x32_bf16 a[176:179], v[156:159], v[188:191], a[176:179]
v_cvt_pk_bf16_f32 v194, v184, v185
v_add_f32 v220, v220, v186
v_mfma_f32_16x16x32_bf16 a[180:183], v[160:163], v[188:191], a[180:183]
v_cvt_pk_bf16_f32 v195, v186, v187
v_add_f32 v220, v220, v187
v_mfma_f32_16x16x32_bf16 a[184:187], v[164:167], v[188:191], a[184:187]
v_mfma_f32_16x16x32_bf16 a[188:191], v[168:171], v[188:191], a[188:191]
s_waitcnt vmcnt(16)
v_mfma_f32_16x16x32_bf16 v[180:183], v[108:111], v[16:19], v[84:87]
v_exp_f32 v172, v172
v_mfma_f32_16x16x32_bf16 v[180:183], v[112:115], v[20:23], v[180:183]
s_add_u32 m0, s51, 0
s_add_u32 s58, s56, 196608
s_add_u32 s58, s58, s57
buffer_load_dwordx4 v208, s[28:31], s58 offen nt lds
v_exp_f32 v173, v173
v_mfma_f32_16x16x32_bf16 v[180:183], v[116:119], v[24:27], v[180:183]
v_exp_f32 v174, v174
v_mfma_f32_16x16x32_bf16 v[180:183], v[120:123], v[28:31], v[180:183]
v_exp_f32 v175, v175
v_mfma_f32_16x16x32_bf16 a[192:195], v[140:143], v[192:195], a[192:195]
ds_read_b64_tr_b16 v[140:141], v200 offset:0
ds_read_b64_tr_b16 v[142:143], v200 offset:4096
v_add_f32 v214, v214, v172
v_cvt_pk_bf16_f32 v188, v172, v173
v_mfma_f32_16x16x32_bf16 a[196:199], v[144:147], v[192:195], a[196:199]
ds_read_b64_tr_b16 v[144:145], v201 offset:0
ds_read_b64_tr_b16 v[146:147], v201 offset:4096
v_exp_f32 v176, v176
v_mfma_f32_16x16x32_bf16 a[200:203], v[148:151], v[192:195], a[200:203]
ds_read_b64_tr_b16 v[148:149], v202 offset:0
ds_read_b64_tr_b16 v[150:151], v202 offset:4096
buffer_load_dwordx4 v209, s[28:31], s58 offen offset:1024 nt lds
v_add_f32 v214, v214, v173
v_add_f32 v214, v214, v174
v_mfma_f32_16x16x32_bf16 a[204:207], v[152:155], v[192:195], a[204:207]
ds_read_b64_tr_b16 v[152:153], v203 offset:0
ds_read_b64_tr_b16 v[154:155], v203 offset:4096
v_exp_f32 v177, v177
v_mfma_f32_16x16x32_bf16 v[184:187], v[124:127], v[16:19], v[84:87]
v_add_f32 v214, v214, v175
v_cvt_pk_bf16_f32 v189, v174, v175
v_mfma_f32_16x16x32_bf16 v[184:187], v[128:131], v[20:23], v[184:187]
v_exp_f32 v178, v178
v_mfma_f32_16x16x32_bf16 v[184:187], v[132:135], v[24:27], v[184:187]
v_add_f32 v214, v214, v176
v_add_f32 v214, v214, v177
v_mfma_f32_16x16x32_bf16 v[184:187], v[136:139], v[28:31], v[184:187]
buffer_load_dwordx4 v210, s[28:31], s58 offen offset:2048 nt lds
v_exp_f32 v179, v179
v_mfma_f32_16x16x32_bf16 a[208:211], v[156:159], v[192:195], a[208:211]
ds_read_b64_tr_b16 v[156:157], v204 offset:0
ds_read_b64_tr_b16 v[158:159], v204 offset:4096
v_cvt_pk_bf16_f32 v190, v176, v177
v_add_f32 v214, v214, v178
v_mfma_f32_16x16x32_bf16 a[212:215], v[160:163], v[192:195], a[212:215]
ds_read_b64_tr_b16 v[160:161], v205 offset:0
ds_read_b64_tr_b16 v[162:163], v205 offset:4096
v_cvt_pk_bf16_f32 v191, v178, v179
v_add_f32 v214, v214, v179
v_mfma_f32_16x16x32_bf16 a[216:219], v[164:167], v[192:195], a[216:219]
ds_read_b64_tr_b16 v[164:165], v206 offset:0
ds_read_b64_tr_b16 v[166:167], v206 offset:4096
v_mfma_f32_16x16x32_bf16 a[220:223], v[168:171], v[192:195], a[220:223]
ds_read_b64_tr_b16 v[168:169], v207 offset:0
ds_read_b64_tr_b16 v[170:171], v207 offset:4096
s_waitcnt lgkmcnt(8)
v_mfma_f32_16x16x32_bf16 v[172:175], v[108:111], v[32:35], v[88:91]
v_exp_f32 v180, v180
v_mfma_f32_16x16x32_bf16 v[172:175], v[112:115], v[36:39], v[172:175]
buffer_load_dwordx4 v211, s[28:31], s58 offen offset:3072 nt lds
v_exp_f32 v181, v181
v_mfma_f32_16x16x32_bf16 v[172:175], v[116:119], v[40:43], v[172:175]
v_exp_f32 v182, v182
v_mfma_f32_16x16x32_bf16 v[172:175], v[120:123], v[44:47], v[172:175]
v_exp_f32 v183, v183
v_mfma_f32_16x16x32_bf16 a[0:3], v[140:143], v[188:191], a[0:3]
v_add_f32 v215, v215, v180
v_cvt_pk_bf16_f32 v192, v180, v181
v_mfma_f32_16x16x32_bf16 a[4:7], v[144:147], v[188:191], a[4:7]
v_exp_f32 v184, v184
v_mfma_f32_16x16x32_bf16 a[8:11], v[148:151], v[188:191], a[8:11]
s_add_u32 m0, s51, 4096
s_add_u32 s58, s58, 4096
buffer_load_dwordx4 v208, s[28:31], s58 offen nt lds
v_add_f32 v215, v215, v181
v_add_f32 v215, v215, v182
v_mfma_f32_16x16x32_bf16 a[12:15], v[152:155], v[188:191], a[12:15]
s_waitcnt lgkmcnt(0)
v_exp_f32 v185, v185
v_mfma_f32_16x16x32_bf16 v[176:179], v[124:127], v[32:35], v[88:91]
v_add_f32 v215, v215, v183
v_cvt_pk_bf16_f32 v193, v182, v183
v_mfma_f32_16x16x32_bf16 v[176:179], v[128:131], v[36:39], v[176:179]
v_exp_f32 v186, v186
v_mfma_f32_16x16x32_bf16 v[176:179], v[132:135], v[40:43], v[176:179]
v_add_f32 v215, v215, v184
v_add_f32 v215, v215, v185
v_mfma_f32_16x16x32_bf16 v[176:179], v[136:139], v[44:47], v[176:179]
buffer_load_dwordx4 v209, s[28:31], s58 offen offset:1024 nt lds
v_exp_f32 v187, v187
v_mfma_f32_16x16x32_bf16 a[16:19], v[156:159], v[188:191], a[16:19]
v_cvt_pk_bf16_f32 v194, v184, v185
v_add_f32 v215, v215, v186
v_mfma_f32_16x16x32_bf16 a[20:23], v[160:163], v[188:191], a[20:23]
v_cvt_pk_bf16_f32 v195, v186, v187
v_add_f32 v215, v215, v187
v_mfma_f32_16x16x32_bf16 a[24:27], v[164:167], v[188:191], a[24:27]
v_mfma_f32_16x16x32_bf16 a[28:31], v[168:171], v[188:191], a[28:31]
v_mfma_f32_16x16x32_bf16 v[180:183], v[108:111], v[48:51], v[92:95]
v_exp_f32 v172, v172
v_mfma_f32_16x16x32_bf16 v[180:183], v[112:115], v[52:55], v[180:183]
buffer_load_dwordx4 v210, s[28:31], s58 offen offset:2048 nt lds
v_exp_f32 v173, v173
v_mfma_f32_16x16x32_bf16 v[180:183], v[116:119], v[56:59], v[180:183]
v_exp_f32 v174, v174
v_mfma_f32_16x16x32_bf16 v[180:183], v[120:123], v[60:63], v[180:183]
v_exp_f32 v175, v175
v_mfma_f32_16x16x32_bf16 a[32:35], v[140:143], v[192:195], a[32:35]
v_add_f32 v216, v216, v172
v_cvt_pk_bf16_f32 v188, v172, v173
v_mfma_f32_16x16x32_bf16 a[36:39], v[144:147], v[192:195], a[36:39]
v_exp_f32 v176, v176
v_mfma_f32_16x16x32_bf16 a[40:43], v[148:151], v[192:195], a[40:43]
v_add_f32 v216, v216, v173
v_add_f32 v216, v216, v174
v_mfma_f32_16x16x32_bf16 a[44:47], v[152:155], v[192:195], a[44:47]
v_exp_f32 v177, v177
v_mfma_f32_16x16x32_bf16 v[184:187], v[124:127], v[48:51], v[92:95]
v_add_f32 v216, v216, v175
v_cvt_pk_bf16_f32 v189, v174, v175
v_mfma_f32_16x16x32_bf16 v[184:187], v[128:131], v[52:55], v[184:187]
buffer_load_dwordx4 v211, s[28:31], s58 offen offset:3072 nt lds
v_exp_f32 v178, v178
v_mfma_f32_16x16x32_bf16 v[184:187], v[132:135], v[56:59], v[184:187]
v_add_f32 v216, v216, v176
v_add_f32 v216, v216, v177
v_mfma_f32_16x16x32_bf16 v[184:187], v[136:139], v[60:63], v[184:187]
v_exp_f32 v179, v179
v_mfma_f32_16x16x32_bf16 a[48:51], v[156:159], v[192:195], a[48:51]
v_cvt_pk_bf16_f32 v190, v176, v177
v_add_f32 v216, v216, v178
v_mfma_f32_16x16x32_bf16 a[52:55], v[160:163], v[192:195], a[52:55]
v_cvt_pk_bf16_f32 v191, v178, v179
v_add_f32 v216, v216, v179
v_mfma_f32_16x16x32_bf16 a[56:59], v[164:167], v[192:195], a[56:59]
v_mfma_f32_16x16x32_bf16 a[60:63], v[168:171], v[192:195], a[60:63]
v_mfma_f32_16x16x32_bf16 v[172:175], v[108:111], v[64:67], v[96:99]
v_exp_f32 v180, v180
v_mfma_f32_16x16x32_bf16 v[172:175], v[112:115], v[68:71], v[172:175]
s_add_u32 m0, s51, 16384
s_add_u32 s58, s56, 196608
s_add_u32 s58, s58, s57
buffer_load_dwordx4 v212, s[32:35], s58 offen nt lds
v_exp_f32 v181, v181
v_mfma_f32_16x16x32_bf16 v[172:175], v[116:119], v[72:75], v[172:175]
v_exp_f32 v182, v182
v_mfma_f32_16x16x32_bf16 v[172:175], v[120:123], v[76:79], v[172:175]
v_exp_f32 v183, v183
v_mfma_f32_16x16x32_bf16 a[64:67], v[140:143], v[188:191], a[64:67]
v_add_f32 v217, v217, v180
v_cvt_pk_bf16_f32 v192, v180, v181
v_mfma_f32_16x16x32_bf16 a[68:71], v[144:147], v[188:191], a[68:71]
v_exp_f32 v184, v184
v_mfma_f32_16x16x32_bf16 a[72:75], v[148:151], v[188:191], a[72:75]
v_add_f32 v217, v217, v181
v_add_f32 v217, v217, v182
v_mfma_f32_16x16x32_bf16 a[76:79], v[152:155], v[188:191], a[76:79]
v_exp_f32 v185, v185
v_mfma_f32_16x16x32_bf16 v[176:179], v[124:127], v[64:67], v[96:99]
v_add_f32 v217, v217, v183
v_cvt_pk_bf16_f32 v193, v182, v183
v_mfma_f32_16x16x32_bf16 v[176:179], v[128:131], v[68:71], v[176:179]
buffer_load_dwordx4 v213, s[32:35], s58 offen offset:1024 nt lds
v_exp_f32 v186, v186
v_mfma_f32_16x16x32_bf16 v[176:179], v[132:135], v[72:75], v[176:179]
v_add_f32 v217, v217, v184
v_add_f32 v217, v217, v185
v_mfma_f32_16x16x32_bf16 v[176:179], v[136:139], v[76:79], v[176:179]
v_exp_f32 v187, v187
v_mfma_f32_16x16x32_bf16 a[80:83], v[156:159], v[188:191], a[80:83]
v_cvt_pk_bf16_f32 v194, v184, v185
v_add_f32 v217, v217, v186
v_mfma_f32_16x16x32_bf16 a[84:87], v[160:163], v[188:191], a[84:87]
v_cvt_pk_bf16_f32 v195, v186, v187
v_add_f32 v217, v217, v187
v_mfma_f32_16x16x32_bf16 a[88:91], v[164:167], v[188:191], a[88:91]
v_mfma_f32_16x16x32_bf16 a[92:95], v[168:171], v[188:191], a[92:95]
v_mfma_f32_16x16x32_bf16 v[180:183], v[108:111], a[224:227], v[100:103]
v_exp_f32 v172, v172
v_mfma_f32_16x16x32_bf16 v[180:183], v[112:115], a[228:231], v[180:183]
buffer_load_dwordx4 v212, s[32:35], s58 offen offset:2048 nt lds
v_exp_f32 v173, v173
v_mfma_f32_16x16x32_bf16 v[180:183], v[116:119], a[232:235], v[180:183]
v_exp_f32 v174, v174
v_mfma_f32_16x16x32_bf16 v[180:183], v[120:123], a[236:239], v[180:183]
v_exp_f32 v175, v175
v_mfma_f32_16x16x32_bf16 a[96:99], v[140:143], v[192:195], a[96:99]
v_add_f32 v218, v218, v172
v_cvt_pk_bf16_f32 v188, v172, v173
v_mfma_f32_16x16x32_bf16 a[100:103], v[144:147], v[192:195], a[100:103]
v_exp_f32 v176, v176
v_mfma_f32_16x16x32_bf16 a[104:107], v[148:151], v[192:195], a[104:107]
v_add_f32 v218, v218, v173
v_add_f32 v218, v218, v174
v_mfma_f32_16x16x32_bf16 a[108:111], v[152:155], v[192:195], a[108:111]
v_exp_f32 v177, v177
v_mfma_f32_16x16x32_bf16 v[184:187], v[124:127], a[224:227], v[100:103]
v_add_f32 v218, v218, v175
v_cvt_pk_bf16_f32 v189, v174, v175
v_mfma_f32_16x16x32_bf16 v[184:187], v[128:131], a[228:231], v[184:187]
buffer_load_dwordx4 v213, s[32:35], s58 offen offset:3072 nt lds
v_exp_f32 v178, v178
v_mfma_f32_16x16x32_bf16 v[184:187], v[132:135], a[232:235], v[184:187]
v_add_f32 v218, v218, v176
v_add_f32 v218, v218, v177
v_mfma_f32_16x16x32_bf16 v[184:187], v[136:139], a[236:239], v[184:187]
v_exp_f32 v179, v179
v_mfma_f32_16x16x32_bf16 a[112:115], v[156:159], v[192:195], a[112:115]
v_cvt_pk_bf16_f32 v190, v176, v177
v_add_f32 v218, v218, v178
v_mfma_f32_16x16x32_bf16 a[116:119], v[160:163], v[192:195], a[116:119]
v_cvt_pk_bf16_f32 v191, v178, v179
v_add_f32 v218, v218, v179
v_mfma_f32_16x16x32_bf16 a[120:123], v[164:167], v[192:195], a[120:123]
v_mfma_f32_16x16x32_bf16 a[124:127], v[168:171], v[192:195], a[124:127]
s_waitcnt vmcnt(20)
v_mfma_f32_16x16x32_bf16 v[172:175], v[108:111], a[240:243], v[104:107]
ds_read_b128 v[108:111], v196 offset:8192
v_exp_f32 v180, v180
v_mfma_f32_16x16x32_bf16 v[172:175], v[112:115], a[244:247], v[172:175]
ds_read_b128 v[112:115], v197 offset:8192
s_add_u32 m0, s51, 20480
s_add_u32 s58, s58, 4096
buffer_load_dwordx4 v212, s[32:35], s58 offen nt lds
v_exp_f32 v181, v181
v_mfma_f32_16x16x32_bf16 v[172:175], v[116:119], a[248:251], v[172:175]
ds_read_b128 v[116:119], v198 offset:8192
v_exp_f32 v182, v182
v_mfma_f32_16x16x32_bf16 v[172:175], v[120:123], a[252:255], v[172:175]
ds_read_b128 v[120:123], v199 offset:8192
v_exp_f32 v183, v183
v_mfma_f32_16x16x32_bf16 a[128:131], v[140:143], v[188:191], a[128:131]
v_add_f32 v219, v219, v180
v_cvt_pk_bf16_f32 v192, v180, v181
v_mfma_f32_16x16x32_bf16 a[132:135], v[144:147], v[188:191], a[132:135]
v_exp_f32 v184, v184
v_mfma_f32_16x16x32_bf16 a[136:139], v[148:151], v[188:191], a[136:139]
v_add_f32 v219, v219, v181
v_add_f32 v219, v219, v182
v_mfma_f32_16x16x32_bf16 a[140:143], v[152:155], v[188:191], a[140:143]
v_exp_f32 v185, v185
v_mfma_f32_16x16x32_bf16 v[176:179], v[124:127], a[240:243], v[104:107]
ds_read_b128 v[124:127], v196 offset:12288
v_add_f32 v219, v219, v183
v_cvt_pk_bf16_f32 v193, v182, v183
v_mfma_f32_16x16x32_bf16 v[176:179], v[128:131], a[244:247], v[176:179]
ds_read_b128 v[128:131], v197 offset:12288
buffer_load_dwordx4 v213, s[32:35], s58 offen offset:1024 nt lds
v_exp_f32 v186, v186
v_mfma_f32_16x16x32_bf16 v[176:179], v[132:135], a[248:251], v[176:179]
ds_read_b128 v[132:135], v198 offset:12288
v_add_f32 v219, v219, v184
v_add_f32 v219, v219, v185
v_mfma_f32_16x16x32_bf16 v[176:179], v[136:139], a[252:255], v[176:179]
ds_read_b128 v[136:139], v199 offset:12288
v_exp_f32 v187, v187
v_mfma_f32_16x16x32_bf16 a[144:147], v[156:159], v[188:191], a[144:147]
v_cvt_pk_bf16_f32 v194, v184, v185
v_add_f32 v219, v219, v186
v_mfma_f32_16x16x32_bf16 a[148:151], v[160:163], v[188:191], a[148:151]
v_cvt_pk_bf16_f32 v195, v186, v187
v_add_f32 v219, v219, v187
v_mfma_f32_16x16x32_bf16 a[152:155], v[164:167], v[188:191], a[152:155]
v_mfma_f32_16x16x32_bf16 a[156:159], v[168:171], v[188:191], a[156:159]
s_waitcnt lgkmcnt(4)
v_mfma_f32_16x16x32_bf16 v[180:183], v[108:111], v[0:3], v[80:83]
v_exp_f32 v172, v172
v_mfma_f32_16x16x32_bf16 v[180:183], v[112:115], v[4:7], v[180:183]
buffer_load_dwordx4 v212, s[32:35], s58 offen offset:2048 nt lds
v_exp_f32 v173, v173
v_mfma_f32_16x16x32_bf16 v[180:183], v[116:119], v[8:11], v[180:183]
v_exp_f32 v174, v174
v_mfma_f32_16x16x32_bf16 v[180:183], v[120:123], v[12:15], v[180:183]
s_waitcnt lgkmcnt(0)
v_exp_f32 v175, v175
v_mfma_f32_16x16x32_bf16 a[160:163], v[140:143], v[192:195], a[160:163]
v_add_f32 v220, v220, v172
v_cvt_pk_bf16_f32 v188, v172, v173
v_mfma_f32_16x16x32_bf16 a[164:167], v[144:147], v[192:195], a[164:167]
v_exp_f32 v176, v176
v_mfma_f32_16x16x32_bf16 a[168:171], v[148:151], v[192:195], a[168:171]
v_add_f32 v220, v220, v173
v_add_f32 v220, v220, v174
v_mfma_f32_16x16x32_bf16 a[172:175], v[152:155], v[192:195], a[172:175]
v_exp_f32 v177, v177
v_mfma_f32_16x16x32_bf16 v[184:187], v[124:127], v[0:3], v[80:83]
v_add_f32 v220, v220, v175
v_cvt_pk_bf16_f32 v189, v174, v175
v_mfma_f32_16x16x32_bf16 v[184:187], v[128:131], v[4:7], v[184:187]
buffer_load_dwordx4 v213, s[32:35], s58 offen offset:3072 nt lds
v_exp_f32 v178, v178
v_mfma_f32_16x16x32_bf16 v[184:187], v[132:135], v[8:11], v[184:187]
v_add_f32 v220, v220, v176
v_add_f32 v220, v220, v177
v_mfma_f32_16x16x32_bf16 v[184:187], v[136:139], v[12:15], v[184:187]
v_exp_f32 v179, v179
v_mfma_f32_16x16x32_bf16 a[176:179], v[156:159], v[192:195], a[176:179]
v_cvt_pk_bf16_f32 v190, v176, v177
v_add_f32 v220, v220, v178
v_mfma_f32_16x16x32_bf16 a[180:183], v[160:163], v[192:195], a[180:183]
v_cvt_pk_bf16_f32 v191, v178, v179
v_add_f32 v220, v220, v179
v_mfma_f32_16x16x32_bf16 a[184:187], v[164:167], v[192:195], a[184:187]
v_mfma_f32_16x16x32_bf16 a[188:191], v[168:171], v[192:195], a[188:191]
s_waitcnt vmcnt(16)
v_mfma_f32_16x16x32_bf16 v[172:175], v[108:111], v[16:19], v[84:87]
v_exp_f32 v180, v180
v_mfma_f32_16x16x32_bf16 v[172:175], v[112:115], v[20:23], v[172:175]
s_add_u32 m0, s51, 8192
s_add_u32 s58, s56, 229376
s_sub_u32 s58, s58, s57
buffer_load_dwordx4 v208, s[28:31], s58 offen nt lds
v_exp_f32 v181, v181
v_mfma_f32_16x16x32_bf16 v[172:175], v[116:119], v[24:27], v[172:175]
v_exp_f32 v182, v182
v_mfma_f32_16x16x32_bf16 v[172:175], v[120:123], v[28:31], v[172:175]
v_exp_f32 v183, v183
v_mfma_f32_16x16x32_bf16 a[192:195], v[140:143], v[188:191], a[192:195]
ds_read_b64_tr_b16 v[140:141], v200 offset:8192
ds_read_b64_tr_b16 v[142:143], v200 offset:12288
v_add_f32 v214, v214, v180
v_cvt_pk_bf16_f32 v192, v180, v181
v_mfma_f32_16x16x32_bf16 a[196:199], v[144:147], v[188:191], a[196:199]
ds_read_b64_tr_b16 v[144:145], v201 offset:8192
ds_read_b64_tr_b16 v[146:147], v201 offset:12288
v_exp_f32 v184, v184
v_mfma_f32_16x16x32_bf16 a[200:203], v[148:151], v[188:191], a[200:203]
ds_read_b64_tr_b16 v[148:149], v202 offset:8192
ds_read_b64_tr_b16 v[150:151], v202 offset:12288
buffer_load_dwordx4 v209, s[28:31], s58 offen offset:1024 nt lds
v_add_f32 v214, v214, v181
v_add_f32 v214, v214, v182
v_mfma_f32_16x16x32_bf16 a[204:207], v[152:155], v[188:191], a[204:207]
ds_read_b64_tr_b16 v[152:153], v203 offset:8192
ds_read_b64_tr_b16 v[154:155], v203 offset:12288
v_exp_f32 v185, v185
v_mfma_f32_16x16x32_bf16 v[176:179], v[124:127], v[16:19], v[84:87]
v_add_f32 v214, v214, v183
v_cvt_pk_bf16_f32 v193, v182, v183
v_mfma_f32_16x16x32_bf16 v[176:179], v[128:131], v[20:23], v[176:179]
v_exp_f32 v186, v186
v_mfma_f32_16x16x32_bf16 v[176:179], v[132:135], v[24:27], v[176:179]
v_add_f32 v214, v214, v184
v_add_f32 v214, v214, v185
v_mfma_f32_16x16x32_bf16 v[176:179], v[136:139], v[28:31], v[176:179]
buffer_load_dwordx4 v210, s[28:31], s58 offen offset:2048 nt lds
v_exp_f32 v187, v187
v_mfma_f32_16x16x32_bf16 a[208:211], v[156:159], v[188:191], a[208:211]
ds_read_b64_tr_b16 v[156:157], v204 offset:8192
ds_read_b64_tr_b16 v[158:159], v204 offset:12288
v_cvt_pk_bf16_f32 v194, v184, v185
v_add_f32 v214, v214, v186
v_mfma_f32_16x16x32_bf16 a[212:215], v[160:163], v[188:191], a[212:215]
ds_read_b64_tr_b16 v[160:161], v205 offset:8192
ds_read_b64_tr_b16 v[162:163], v205 offset:12288
v_cvt_pk_bf16_f32 v195, v186, v187
v_add_f32 v214, v214, v187
v_mfma_f32_16x16x32_bf16 a[216:219], v[164:167], v[188:191], a[216:219]
ds_read_b64_tr_b16 v[164:165], v206 offset:8192
ds_read_b64_tr_b16 v[166:167], v206 offset:12288
v_mfma_f32_16x16x32_bf16 a[220:223], v[168:171], v[188:191], a[220:223]
ds_read_b64_tr_b16 v[168:169], v207 offset:8192
ds_read_b64_tr_b16 v[170:171], v207 offset:12288
s_waitcnt lgkmcnt(8)
v_mfma_f32_16x16x32_bf16 v[180:183], v[108:111], v[32:35], v[88:91]
v_exp_f32 v172, v172
v_mfma_f32_16x16x32_bf16 v[180:183], v[112:115], v[36:39], v[180:183]
buffer_load_dwordx4 v211, s[28:31], s58 offen offset:3072 nt lds
v_exp_f32 v173, v173
v_mfma_f32_16x16x32_bf16 v[180:183], v[116:119], v[40:43], v[180:183]
v_exp_f32 v174, v174
v_mfma_f32_16x16x32_bf16 v[180:183], v[120:123], v[44:47], v[180:183]
v_exp_f32 v175, v175
v_mfma_f32_16x16x32_bf16 a[0:3], v[140:143], v[192:195], a[0:3]
v_add_f32 v215, v215, v172
v_cvt_pk_bf16_f32 v188, v172, v173
v_mfma_f32_16x16x32_bf16 a[4:7], v[144:147], v[192:195], a[4:7]
v_exp_f32 v176, v176
v_mfma_f32_16x16x32_bf16 a[8:11], v[148:151], v[192:195], a[8:11]
s_add_u32 m0, s51, 12288
s_add_u32 s58, s58, 4096
buffer_load_dwordx4 v208, s[28:31], s58 offen nt lds
v_add_f32 v215, v215, v173
v_add_f32 v215, v215, v174
v_mfma_f32_16x16x32_bf16 a[12:15], v[152:155], v[192:195], a[12:15]
s_waitcnt lgkmcnt(0)
v_exp_f32 v177, v177
v_mfma_f32_16x16x32_bf16 v[184:187], v[124:127], v[32:35], v[88:91]
v_add_f32 v215, v215, v175
v_cvt_pk_bf16_f32 v189, v174, v175
v_mfma_f32_16x16x32_bf16 v[184:187], v[128:131], v[36:39], v[184:187]
v_exp_f32 v178, v178
v_mfma_f32_16x16x32_bf16 v[184:187], v[132:135], v[40:43], v[184:187]
v_add_f32 v215, v215, v176
v_add_f32 v215, v215, v177
v_mfma_f32_16x16x32_bf16 v[184:187], v[136:139], v[44:47], v[184:187]
buffer_load_dwordx4 v209, s[28:31], s58 offen offset:1024 nt lds
v_exp_f32 v179, v179
v_mfma_f32_16x16x32_bf16 a[16:19], v[156:159], v[192:195], a[16:19]
v_cvt_pk_bf16_f32 v190, v176, v177
v_add_f32 v215, v215, v178
v_mfma_f32_16x16x32_bf16 a[20:23], v[160:163], v[192:195], a[20:23]
v_cvt_pk_bf16_f32 v191, v178, v179
v_add_f32 v215, v215, v179
v_mfma_f32_16x16x32_bf16 a[24:27], v[164:167], v[192:195], a[24:27]
v_mfma_f32_16x16x32_bf16 a[28:31], v[168:171], v[192:195], a[28:31]
v_mfma_f32_16x16x32_bf16 v[172:175], v[108:111], v[48:51], v[92:95]
v_exp_f32 v180, v180
v_mfma_f32_16x16x32_bf16 v[172:175], v[112:115], v[52:55], v[172:175]
buffer_load_dwordx4 v210, s[28:31], s58 offen offset:2048 nt lds
v_exp_f32 v181, v181
v_mfma_f32_16x16x32_bf16 v[172:175], v[116:119], v[56:59], v[172:175]
v_exp_f32 v182, v182
v_mfma_f32_16x16x32_bf16 v[172:175], v[120:123], v[60:63], v[172:175]
v_exp_f32 v183, v183
v_mfma_f32_16x16x32_bf16 a[32:35], v[140:143], v[188:191], a[32:35]
v_add_f32 v216, v216, v180
v_cvt_pk_bf16_f32 v192, v180, v181
v_mfma_f32_16x16x32_bf16 a[36:39], v[144:147], v[188:191], a[36:39]
v_exp_f32 v184, v184
v_mfma_f32_16x16x32_bf16 a[40:43], v[148:151], v[188:191], a[40:43]
v_add_f32 v216, v216, v181
v_add_f32 v216, v216, v182
v_mfma_f32_16x16x32_bf16 a[44:47], v[152:155], v[188:191], a[44:47]
v_exp_f32 v185, v185
v_mfma_f32_16x16x32_bf16 v[176:179], v[124:127], v[48:51], v[92:95]
v_add_f32 v216, v216, v183
v_cvt_pk_bf16_f32 v193, v182, v183
v_mfma_f32_16x16x32_bf16 v[176:179], v[128:131], v[52:55], v[176:179]
buffer_load_dwordx4 v211, s[28:31], s58 offen offset:3072 nt lds
v_exp_f32 v186, v186
v_mfma_f32_16x16x32_bf16 v[176:179], v[132:135], v[56:59], v[176:179]
v_add_f32 v216, v216, v184
v_add_f32 v216, v216, v185
v_mfma_f32_16x16x32_bf16 v[176:179], v[136:139], v[60:63], v[176:179]
v_exp_f32 v187, v187
v_mfma_f32_16x16x32_bf16 a[48:51], v[156:159], v[188:191], a[48:51]
v_cvt_pk_bf16_f32 v194, v184, v185
v_add_f32 v216, v216, v186
v_mfma_f32_16x16x32_bf16 a[52:55], v[160:163], v[188:191], a[52:55]
v_cvt_pk_bf16_f32 v195, v186, v187
v_add_f32 v216, v216, v187
v_mfma_f32_16x16x32_bf16 a[56:59], v[164:167], v[188:191], a[56:59]
v_mfma_f32_16x16x32_bf16 a[60:63], v[168:171], v[188:191], a[60:63]
v_mfma_f32_16x16x32_bf16 v[180:183], v[108:111], v[64:67], v[96:99]
v_exp_f32 v172, v172
v_mfma_f32_16x16x32_bf16 v[180:183], v[112:115], v[68:71], v[180:183]
s_add_u32 m0, s51, 24576
s_add_u32 s58, s56, 229376
s_sub_u32 s58, s58, s57
buffer_load_dwordx4 v212, s[32:35], s58 offen nt lds
v_exp_f32 v173, v173
v_mfma_f32_16x16x32_bf16 v[180:183], v[116:119], v[72:75], v[180:183]
v_exp_f32 v174, v174
v_mfma_f32_16x16x32_bf16 v[180:183], v[120:123], v[76:79], v[180:183]
v_exp_f32 v175, v175
v_mfma_f32_16x16x32_bf16 a[64:67], v[140:143], v[192:195], a[64:67]
v_add_f32 v217, v217, v172
v_cvt_pk_bf16_f32 v188, v172, v173
v_mfma_f32_16x16x32_bf16 a[68:71], v[144:147], v[192:195], a[68:71]
v_exp_f32 v176, v176
v_mfma_f32_16x16x32_bf16 a[72:75], v[148:151], v[192:195], a[72:75]
v_add_f32 v217, v217, v173
v_add_f32 v217, v217, v174
v_mfma_f32_16x16x32_bf16 a[76:79], v[152:155], v[192:195], a[76:79]
v_exp_f32 v177, v177
v_mfma_f32_16x16x32_bf16 v[184:187], v[124:127], v[64:67], v[96:99]
v_add_f32 v217, v217, v175
v_cvt_pk_bf16_f32 v189, v174, v175
v_mfma_f32_16x16x32_bf16 v[184:187], v[128:131], v[68:71], v[184:187]
buffer_load_dwordx4 v213, s[32:35], s58 offen offset:1024 nt lds
v_exp_f32 v178, v178
v_mfma_f32_16x16x32_bf16 v[184:187], v[132:135], v[72:75], v[184:187]
v_add_f32 v217, v217, v176
v_add_f32 v217, v217, v177
v_mfma_f32_16x16x32_bf16 v[184:187], v[136:139], v[76:79], v[184:187]
v_exp_f32 v179, v179
v_mfma_f32_16x16x32_bf16 a[80:83], v[156:159], v[192:195], a[80:83]
v_cvt_pk_bf16_f32 v190, v176, v177
v_add_f32 v217, v217, v178
v_mfma_f32_16x16x32_bf16 a[84:87], v[160:163], v[192:195], a[84:87]
v_cvt_pk_bf16_f32 v191, v178, v179
v_add_f32 v217, v217, v179
v_mfma_f32_16x16x32_bf16 a[88:91], v[164:167], v[192:195], a[88:91]
v_mfma_f32_16x16x32_bf16 a[92:95], v[168:171], v[192:195], a[92:95]
v_mfma_f32_16x16x32_bf16 v[172:175], v[108:111], a[224:227], v[100:103]
v_exp_f32 v180, v180
v_mfma_f32_16x16x32_bf16 v[172:175], v[112:115], a[228:231], v[172:175]
buffer_load_dwordx4 v212, s[32:35], s58 offen offset:2048 nt lds
v_exp_f32 v181, v181
v_mfma_f32_16x16x32_bf16 v[172:175], v[116:119], a[232:235], v[172:175]
v_exp_f32 v182, v182
v_mfma_f32_16x16x32_bf16 v[172:175], v[120:123], a[236:239], v[172:175]
v_exp_f32 v183, v183
v_mfma_f32_16x16x32_bf16 a[96:99], v[140:143], v[188:191], a[96:99]
v_add_f32 v218, v218, v180
v_cvt_pk_bf16_f32 v192, v180, v181
v_mfma_f32_16x16x32_bf16 a[100:103], v[144:147], v[188:191], a[100:103]
v_exp_f32 v184, v184
v_mfma_f32_16x16x32_bf16 a[104:107], v[148:151], v[188:191], a[104:107]
v_add_f32 v218, v218, v181
v_add_f32 v218, v218, v182
v_mfma_f32_16x16x32_bf16 a[108:111], v[152:155], v[188:191], a[108:111]
v_exp_f32 v185, v185
v_mfma_f32_16x16x32_bf16 v[176:179], v[124:127], a[224:227], v[100:103]
v_add_f32 v218, v218, v183
v_cvt_pk_bf16_f32 v193, v182, v183
v_mfma_f32_16x16x32_bf16 v[176:179], v[128:131], a[228:231], v[176:179]
buffer_load_dwordx4 v213, s[32:35], s58 offen offset:3072 nt lds
v_exp_f32 v186, v186
v_mfma_f32_16x16x32_bf16 v[176:179], v[132:135], a[232:235], v[176:179]
v_add_f32 v218, v218, v184
v_add_f32 v218, v218, v185
v_mfma_f32_16x16x32_bf16 v[176:179], v[136:139], a[236:239], v[176:179]
v_exp_f32 v187, v187
v_mfma_f32_16x16x32_bf16 a[112:115], v[156:159], v[188:191], a[112:115]
v_cvt_pk_bf16_f32 v194, v184, v185
v_add_f32 v218, v218, v186
v_mfma_f32_16x16x32_bf16 a[116:119], v[160:163], v[188:191], a[116:119]
v_cvt_pk_bf16_f32 v195, v186, v187
v_add_f32 v218, v218, v187
v_mfma_f32_16x16x32_bf16 a[120:123], v[164:167], v[188:191], a[120:123]
v_mfma_f32_16x16x32_bf16 a[124:127], v[168:171], v[188:191], a[124:127]
s_waitcnt vmcnt(20)
v_mfma_f32_16x16x32_bf16 v[180:183], v[108:111], a[240:243], v[104:107]
ds_read_b128 v[108:111], v196 offset:0
v_exp_f32 v172, v172
v_mfma_f32_16x16x32_bf16 v[180:183], v[112:115], a[244:247], v[180:183]
ds_read_b128 v[112:115], v197 offset:0
s_add_u32 m0, s51, 28672
s_add_u32 s58, s58, 4096
buffer_load_dwordx4 v212, s[32:35], s58 offen nt lds
v_exp_f32 v173, v173
v_mfma_f32_16x16x32_bf16 v[180:183], v[116:119], a[248:251], v[180:183]
ds_read_b128 v[116:119], v198 offset:0
v_exp_f32 v174, v174
v_mfma_f32_16x16x32_bf16 v[180:183], v[120:123], a[252:255], v[180:183]
ds_read_b128 v[120:123], v199 offset:0
v_exp_f32 v175, v175
v_mfma_f32_16x16x32_bf16 a[128:131], v[140:143], v[192:195], a[128:131]
v_add_f32 v219, v219, v172
v_cvt_pk_bf16_f32 v188, v172, v173
v_mfma_f32_16x16x32_bf16 a[132:135], v[144:147], v[192:195], a[132:135]
v_exp_f32 v176, v176
v_mfma_f32_16x16x32_bf16 a[136:139], v[148:151], v[192:195], a[136:139]
v_add_f32 v219, v219, v173
v_add_f32 v219, v219, v174
v_mfma_f32_16x16x32_bf16 a[140:143], v[152:155], v[192:195], a[140:143]
v_exp_f32 v177, v177
v_mfma_f32_16x16x32_bf16 v[184:187], v[124:127], a[240:243], v[104:107]
ds_read_b128 v[124:127], v196 offset:4096
v_add_f32 v219, v219, v175
v_cvt_pk_bf16_f32 v189, v174, v175
v_mfma_f32_16x16x32_bf16 v[184:187], v[128:131], a[244:247], v[184:187]
ds_read_b128 v[128:131], v197 offset:4096
buffer_load_dwordx4 v213, s[32:35], s58 offen offset:1024 nt lds
v_exp_f32 v178, v178
v_mfma_f32_16x16x32_bf16 v[184:187], v[132:135], a[248:251], v[184:187]
ds_read_b128 v[132:135], v198 offset:4096
v_add_f32 v219, v219, v176
v_add_f32 v219, v219, v177
v_mfma_f32_16x16x32_bf16 v[184:187], v[136:139], a[252:255], v[184:187]
ds_read_b128 v[136:139], v199 offset:4096
v_exp_f32 v179, v179
v_mfma_f32_16x16x32_bf16 a[144:147], v[156:159], v[192:195], a[144:147]
v_cvt_pk_bf16_f32 v190, v176, v177
v_add_f32 v219, v219, v178
v_mfma_f32_16x16x32_bf16 a[148:151], v[160:163], v[192:195], a[148:151]
v_cvt_pk_bf16_f32 v191, v178, v179
v_add_f32 v219, v219, v179
v_mfma_f32_16x16x32_bf16 a[152:155], v[164:167], v[192:195], a[152:155]
v_mfma_f32_16x16x32_bf16 a[156:159], v[168:171], v[192:195], a[156:159]
s_waitcnt lgkmcnt(4)
v_mfma_f32_16x16x32_bf16 v[172:175], v[108:111], v[0:3], v[80:83]
v_exp_f32 v180, v180
v_mfma_f32_16x16x32_bf16 v[172:175], v[112:115], v[4:7], v[172:175]
buffer_load_dwordx4 v212, s[32:35], s58 offen offset:2048 nt lds
v_exp_f32 v181, v181
v_mfma_f32_16x16x32_bf16 v[172:175], v[116:119], v[8:11], v[172:175]
v_exp_f32 v182, v182
v_mfma_f32_16x16x32_bf16 v[172:175], v[120:123], v[12:15], v[172:175]
s_waitcnt lgkmcnt(0)
v_exp_f32 v183, v183
v_mfma_f32_16x16x32_bf16 a[160:163], v[140:143], v[188:191], a[160:163]
v_add_f32 v220, v220, v180
v_cvt_pk_bf16_f32 v192, v180, v181
v_mfma_f32_16x16x32_bf16 a[164:167], v[144:147], v[188:191], a[164:167]
v_exp_f32 v184, v184
v_mfma_f32_16x16x32_bf16 a[168:171], v[148:151], v[188:191], a[168:171]
v_add_f32 v220, v220, v181
v_add_f32 v220, v220, v182
v_mfma_f32_16x16x32_bf16 a[172:175], v[152:155], v[188:191], a[172:175]
v_exp_f32 v185, v185
v_mfma_f32_16x16x32_bf16 v[176:179], v[124:127], v[0:3], v[80:83]
v_add_f32 v220, v220, v183
v_cvt_pk_bf16_f32 v193, v182, v183
v_mfma_f32_16x16x32_bf16 v[176:179], v[128:131], v[4:7], v[176:179]
buffer_load_dwordx4 v213, s[32:35], s58 offen offset:3072 nt lds
v_exp_f32 v186, v186
v_mfma_f32_16x16x32_bf16 v[176:179], v[132:135], v[8:11], v[176:179]
v_add_f32 v220, v220, v184
v_add_f32 v220, v220, v185
v_mfma_f32_16x16x32_bf16 v[176:179], v[136:139], v[12:15], v[176:179]
v_exp_f32 v187, v187
v_mfma_f32_16x16x32_bf16 a[176:179], v[156:159], v[188:191], a[176:179]
v_cvt_pk_bf16_f32 v194, v184, v185
v_add_f32 v220, v220, v186
v_mfma_f32_16x16x32_bf16 a[180:183], v[160:163], v[188:191], a[180:183]
v_cvt_pk_bf16_f32 v195, v186, v187
v_add_f32 v220, v220, v187
v_mfma_f32_16x16x32_bf16 a[184:187], v[164:167], v[188:191], a[184:187]
v_mfma_f32_16x16x32_bf16 a[188:191], v[168:171], v[188:191], a[188:191]
s_waitcnt vmcnt(16)
v_mfma_f32_16x16x32_bf16 v[180:183], v[108:111], v[16:19], v[84:87]
v_exp_f32 v172, v172
v_mfma_f32_16x16x32_bf16 v[180:183], v[112:115], v[20:23], v[180:183]
v_exp_f32 v173, v173
v_mfma_f32_16x16x32_bf16 v[180:183], v[116:119], v[24:27], v[180:183]
v_exp_f32 v174, v174
v_mfma_f32_16x16x32_bf16 v[180:183], v[120:123], v[28:31], v[180:183]
v_exp_f32 v175, v175
v_mfma_f32_16x16x32_bf16 a[192:195], v[140:143], v[192:195], a[192:195]
ds_read_b64_tr_b16 v[140:141], v200 offset:0
ds_read_b64_tr_b16 v[142:143], v200 offset:4096
v_add_f32 v214, v214, v172
v_cvt_pk_bf16_f32 v188, v172, v173
v_mfma_f32_16x16x32_bf16 a[196:199], v[144:147], v[192:195], a[196:199]
ds_read_b64_tr_b16 v[144:145], v201 offset:0
ds_read_b64_tr_b16 v[146:147], v201 offset:4096
v_exp_f32 v176, v176
v_mfma_f32_16x16x32_bf16 a[200:203], v[148:151], v[192:195], a[200:203]
ds_read_b64_tr_b16 v[148:149], v202 offset:0
ds_read_b64_tr_b16 v[150:151], v202 offset:4096
v_add_f32 v214, v214, v173
v_add_f32 v214, v214, v174
v_mfma_f32_16x16x32_bf16 a[204:207], v[152:155], v[192:195], a[204:207]
ds_read_b64_tr_b16 v[152:153], v203 offset:0
ds_read_b64_tr_b16 v[154:155], v203 offset:4096
v_exp_f32 v177, v177
v_mfma_f32_16x16x32_bf16 v[184:187], v[124:127], v[16:19], v[84:87]
v_add_f32 v214, v214, v175
v_cvt_pk_bf16_f32 v189, v174, v175
v_mfma_f32_16x16x32_bf16 v[184:187], v[128:131], v[20:23], v[184:187]
v_exp_f32 v178, v178
v_mfma_f32_16x16x32_bf16 v[184:187], v[132:135], v[24:27], v[184:187]
v_add_f32 v214, v214, v176
v_add_f32 v214, v214, v177
v_mfma_f32_16x16x32_bf16 v[184:187], v[136:139], v[28:31], v[184:187]
v_exp_f32 v179, v179
v_mfma_f32_16x16x32_bf16 a[208:211], v[156:159], v[192:195], a[208:211]
ds_read_b64_tr_b16 v[156:157], v204 offset:0
ds_read_b64_tr_b16 v[158:159], v204 offset:4096
v_cvt_pk_bf16_f32 v190, v176, v177
v_add_f32 v214, v214, v178
v_mfma_f32_16x16x32_bf16 a[212:215], v[160:163], v[192:195], a[212:215]
ds_read_b64_tr_b16 v[160:161], v205 offset:0
ds_read_b64_tr_b16 v[162:163], v205 offset:4096
v_cvt_pk_bf16_f32 v191, v178, v179
v_add_f32 v214, v214, v179
v_mfma_f32_16x16x32_bf16 a[216:219], v[164:167], v[192:195], a[216:219]
ds_read_b64_tr_b16 v[164:165], v206 offset:0
ds_read_b64_tr_b16 v[166:167], v206 offset:4096
v_mfma_f32_16x16x32_bf16 a[220:223], v[168:171], v[192:195], a[220:223]
ds_read_b64_tr_b16 v[168:169], v207 offset:0
ds_read_b64_tr_b16 v[170:171], v207 offset:4096
s_waitcnt lgkmcnt(8)
v_mfma_f32_16x16x32_bf16 v[172:175], v[108:111], v[32:35], v[88:91]
v_exp_f32 v180, v180
v_mfma_f32_16x16x32_bf16 v[172:175], v[112:115], v[36:39], v[172:175]
v_exp_f32 v181, v181
v_mfma_f32_16x16x32_bf16 v[172:175], v[116:119], v[40:43], v[172:175]
buffer_load_dword v251, v243, s[72:75], 0 offen
v_exp_f32 v182, v182
v_mfma_f32_16x16x32_bf16 v[172:175], v[120:123], v[44:47], v[172:175]
v_exp_f32 v183, v183
v_mfma_f32_16x16x32_bf16 a[0:3], v[140:143], v[188:191], a[0:3]
v_add_f32 v215, v215, v180
v_cvt_pk_bf16_f32 v192, v180, v181
v_mfma_f32_16x16x32_bf16 a[4:7], v[144:147], v[188:191], a[4:7]
v_exp_f32 v184, v184
v_mfma_f32_16x16x32_bf16 a[8:11], v[148:151], v[188:191], a[8:11]
v_add_f32 v215, v215, v181
v_add_f32 v215, v215, v182
v_mfma_f32_16x16x32_bf16 a[12:15], v[152:155], v[188:191], a[12:15]
s_waitcnt lgkmcnt(0)
v_exp_f32 v185, v185
v_mfma_f32_16x16x32_bf16 v[176:179], v[124:127], v[32:35], v[88:91]
v_add_f32 v215, v215, v183
v_cvt_pk_bf16_f32 v193, v182, v183
v_mfma_f32_16x16x32_bf16 v[176:179], v[128:131], v[36:39], v[176:179]
v_exp_f32 v186, v186
v_mfma_f32_16x16x32_bf16 v[176:179], v[132:135], v[40:43], v[176:179]
v_add_f32 v215, v215, v184
v_add_f32 v215, v215, v185
v_mfma_f32_16x16x32_bf16 v[176:179], v[136:139], v[44:47], v[176:179]
v_exp_f32 v187, v187
v_mfma_f32_16x16x32_bf16 a[16:19], v[156:159], v[188:191], a[16:19]
v_cvt_pk_bf16_f32 v194, v184, v185
v_add_f32 v215, v215, v186
v_mfma_f32_16x16x32_bf16 a[20:23], v[160:163], v[188:191], a[20:23]
v_cvt_pk_bf16_f32 v195, v186, v187
v_add_f32 v215, v215, v187
v_mfma_f32_16x16x32_bf16 a[24:27], v[164:167], v[188:191], a[24:27]
v_mfma_f32_16x16x32_bf16 a[28:31], v[168:171], v[188:191], a[28:31]
v_mfma_f32_16x16x32_bf16 v[180:183], v[108:111], v[48:51], v[92:95]
v_exp_f32 v172, v172
v_mfma_f32_16x16x32_bf16 v[180:183], v[112:115], v[52:55], v[180:183]
v_exp_f32 v173, v173
v_mfma_f32_16x16x32_bf16 v[180:183], v[116:119], v[56:59], v[180:183]
v_exp_f32 v174, v174
v_mfma_f32_16x16x32_bf16 v[180:183], v[120:123], v[60:63], v[180:183]
v_exp_f32 v175, v175
v_mfma_f32_16x16x32_bf16 a[32:35], v[140:143], v[192:195], a[32:35]
v_add_f32 v216, v216, v172
v_cvt_pk_bf16_f32 v188, v172, v173
v_mfma_f32_16x16x32_bf16 a[36:39], v[144:147], v[192:195], a[36:39]
v_exp_f32 v176, v176
v_mfma_f32_16x16x32_bf16 a[40:43], v[148:151], v[192:195], a[40:43]
v_add_f32 v216, v216, v173
v_add_f32 v216, v216, v174
v_mfma_f32_16x16x32_bf16 a[44:47], v[152:155], v[192:195], a[44:47]
v_exp_f32 v177, v177
v_mfma_f32_16x16x32_bf16 v[184:187], v[124:127], v[48:51], v[92:95]
v_add_f32 v216, v216, v175
v_cvt_pk_bf16_f32 v189, v174, v175
v_mfma_f32_16x16x32_bf16 v[184:187], v[128:131], v[52:55], v[184:187]
v_exp_f32 v178, v178
v_mfma_f32_16x16x32_bf16 v[184:187], v[132:135], v[56:59], v[184:187]
v_add_f32 v216, v216, v176
v_add_f32 v216, v216, v177
v_mfma_f32_16x16x32_bf16 v[184:187], v[136:139], v[60:63], v[184:187]
v_exp_f32 v179, v179
v_mfma_f32_16x16x32_bf16 a[48:51], v[156:159], v[192:195], a[48:51]
v_cvt_pk_bf16_f32 v190, v176, v177
v_add_f32 v216, v216, v178
v_mfma_f32_16x16x32_bf16 a[52:55], v[160:163], v[192:195], a[52:55]
v_cvt_pk_bf16_f32 v191, v178, v179
v_add_f32 v216, v216, v179
v_mfma_f32_16x16x32_bf16 a[56:59], v[164:167], v[192:195], a[56:59]
v_mfma_f32_16x16x32_bf16 a[60:63], v[168:171], v[192:195], a[60:63]
v_mfma_f32_16x16x32_bf16 v[172:175], v[108:111], v[64:67], v[96:99]
v_exp_f32 v180, v180
v_mfma_f32_16x16x32_bf16 v[172:175], v[112:115], v[68:71], v[172:175]
v_exp_f32 v181, v181
v_mfma_f32_16x16x32_bf16 v[172:175], v[116:119], v[72:75], v[172:175]
v_exp_f32 v182, v182
v_mfma_f32_16x16x32_bf16 v[172:175], v[120:123], v[76:79], v[172:175]
v_exp_f32 v183, v183
v_mfma_f32_16x16x32_bf16 a[64:67], v[140:143], v[188:191], a[64:67]
v_add_f32 v217, v217, v180
v_cvt_pk_bf16_f32 v192, v180, v181
v_mfma_f32_16x16x32_bf16 a[68:71], v[144:147], v[188:191], a[68:71]
v_exp_f32 v184, v184
v_mfma_f32_16x16x32_bf16 a[72:75], v[148:151], v[188:191], a[72:75]
v_add_f32 v217, v217, v181
v_add_f32 v217, v217, v182
v_mfma_f32_16x16x32_bf16 a[76:79], v[152:155], v[188:191], a[76:79]
v_exp_f32 v185, v185
v_mfma_f32_16x16x32_bf16 v[176:179], v[124:127], v[64:67], v[96:99]
v_add_f32 v217, v217, v183
v_cvt_pk_bf16_f32 v193, v182, v183
v_mfma_f32_16x16x32_bf16 v[176:179], v[128:131], v[68:71], v[176:179]
v_exp_f32 v186, v186
v_mfma_f32_16x16x32_bf16 v[176:179], v[132:135], v[72:75], v[176:179]
v_add_f32 v217, v217, v184
v_add_f32 v217, v217, v185
v_mfma_f32_16x16x32_bf16 v[176:179], v[136:139], v[76:79], v[176:179]
v_exp_f32 v187, v187
v_mfma_f32_16x16x32_bf16 a[80:83], v[156:159], v[188:191], a[80:83]
v_cvt_pk_bf16_f32 v194, v184, v185
v_add_f32 v217, v217, v186
v_mfma_f32_16x16x32_bf16 a[84:87], v[160:163], v[188:191], a[84:87]
v_cvt_pk_bf16_f32 v195, v186, v187
v_add_f32 v217, v217, v187
v_mfma_f32_16x16x32_bf16 a[88:91], v[164:167], v[188:191], a[88:91]
v_mfma_f32_16x16x32_bf16 a[92:95], v[168:171], v[188:191], a[92:95]
v_mfma_f32_16x16x32_bf16 v[180:183], v[108:111], a[224:227], v[100:103]
v_exp_f32 v172, v172
v_mfma_f32_16x16x32_bf16 v[180:183], v[112:115], a[228:231], v[180:183]
v_exp_f32 v173, v173
v_mfma_f32_16x16x32_bf16 v[180:183], v[116:119], a[232:235], v[180:183]
buffer_load_dword v251, v254, s[72:75], 0 offen
v_exp_f32 v174, v174
v_mfma_f32_16x16x32_bf16 v[180:183], v[120:123], a[236:239], v[180:183]
v_exp_f32 v175, v175
v_mfma_f32_16x16x32_bf16 a[96:99], v[140:143], v[192:195], a[96:99]
v_add_f32 v218, v218, v172
v_cvt_pk_bf16_f32 v188, v172, v173
v_mfma_f32_16x16x32_bf16 a[100:103], v[144:147], v[192:195], a[100:103]
v_exp_f32 v176, v176
v_mfma_f32_16x16x32_bf16 a[104:107], v[148:151], v[192:195], a[104:107]
v_add_f32 v218, v218, v173
v_add_f32 v218, v218, v174
v_mfma_f32_16x16x32_bf16 a[108:111], v[152:155], v[192:195], a[108:111]
v_exp_f32 v177, v177
v_mfma_f32_16x16x32_bf16 v[184:187], v[124:127], a[224:227], v[100:103]
v_add_f32 v218, v218, v175
v_cvt_pk_bf16_f32 v189, v174, v175
v_mfma_f32_16x16x32_bf16 v[184:187], v[128:131], a[228:231], v[184:187]
v_exp_f32 v178, v178
v_mfma_f32_16x16x32_bf16 v[184:187], v[132:135], a[232:235], v[184:187]
v_add_f32 v218, v218, v176
v_add_f32 v218, v218, v177
v_mfma_f32_16x16x32_bf16 v[184:187], v[136:139], a[236:239], v[184:187]
v_exp_f32 v179, v179
v_mfma_f32_16x16x32_bf16 a[112:115], v[156:159], v[192:195], a[112:115]
v_cvt_pk_bf16_f32 v190, v176, v177
v_add_f32 v218, v218, v178
v_mfma_f32_16x16x32_bf16 a[116:119], v[160:163], v[192:195], a[116:119]
v_cvt_pk_bf16_f32 v191, v178, v179
v_add_f32 v218, v218, v179
v_mfma_f32_16x16x32_bf16 a[120:123], v[164:167], v[192:195], a[120:123]
v_mfma_f32_16x16x32_bf16 a[124:127], v[168:171], v[192:195], a[124:127]
s_waitcnt vmcnt(10)
v_mfma_f32_16x16x32_bf16 v[172:175], v[108:111], a[240:243], v[104:107]
ds_read_b128 v[108:111], v196 offset:8192
v_exp_f32 v180, v180
v_mfma_f32_16x16x32_bf16 v[172:175], v[112:115], a[244:247], v[172:175]
ds_read_b128 v[112:115], v197 offset:8192
v_exp_f32 v181, v181
v_mfma_f32_16x16x32_bf16 v[172:175], v[116:119], a[248:251], v[172:175]
ds_read_b128 v[116:119], v198 offset:8192
v_exp_f32 v182, v182
v_mfma_f32_16x16x32_bf16 v[172:175], v[120:123], a[252:255], v[172:175]
ds_read_b128 v[120:123], v199 offset:8192
v_exp_f32 v183, v183
v_mfma_f32_16x16x32_bf16 a[128:131], v[140:143], v[188:191], a[128:131]
v_add_f32 v219, v219, v180
v_cvt_pk_bf16_f32 v192, v180, v181
v_mfma_f32_16x16x32_bf16 a[132:135], v[144:147], v[188:191], a[132:135]
v_exp_f32 v184, v184
v_mfma_f32_16x16x32_bf16 a[136:139], v[148:151], v[188:191], a[136:139]
v_add_f32 v219, v219, v181
v_add_f32 v219, v219, v182
v_mfma_f32_16x16x32_bf16 a[140:143], v[152:155], v[188:191], a[140:143]
v_exp_f32 v185, v185
v_mfma_f32_16x16x32_bf16 v[176:179], v[124:127], a[240:243], v[104:107]
ds_read_b128 v[124:127], v196 offset:12288
v_add_f32 v219, v219, v183
v_cvt_pk_bf16_f32 v193, v182, v183
v_mfma_f32_16x16x32_bf16 v[176:179], v[128:131], a[244:247], v[176:179]
ds_read_b128 v[128:131], v197 offset:12288
v_exp_f32 v186, v186
v_mfma_f32_16x16x32_bf16 v[176:179], v[132:135], a[248:251], v[176:179]
ds_read_b128 v[132:135], v198 offset:12288
v_add_f32 v219, v219, v184
v_add_f32 v219, v219, v185
v_mfma_f32_16x16x32_bf16 v[176:179], v[136:139], a[252:255], v[176:179]
ds_read_b128 v[136:139], v199 offset:12288
v_exp_f32 v187, v187
v_mfma_f32_16x16x32_bf16 a[144:147], v[156:159], v[188:191], a[144:147]
v_cvt_pk_bf16_f32 v194, v184, v185
v_add_f32 v219, v219, v186
v_mfma_f32_16x16x32_bf16 a[148:151], v[160:163], v[188:191], a[148:151]
v_cvt_pk_bf16_f32 v195, v186, v187
v_add_f32 v219, v219, v187
v_mfma_f32_16x16x32_bf16 a[152:155], v[164:167], v[188:191], a[152:155]
v_mfma_f32_16x16x32_bf16 a[156:159], v[168:171], v[188:191], a[156:159]
s_waitcnt lgkmcnt(4)
v_mfma_f32_16x16x32_bf16 v[180:183], v[108:111], v[0:3], v[80:83]
v_exp_f32 v172, v172
v_mfma_f32_16x16x32_bf16 v[180:183], v[112:115], v[4:7], v[180:183]
v_exp_f32 v173, v173
v_mfma_f32_16x16x32_bf16 v[180:183], v[116:119], v[8:11], v[180:183]
v_exp_f32 v174, v174
v_mfma_f32_16x16x32_bf16 v[180:183], v[120:123], v[12:15], v[180:183]
s_waitcnt lgkmcnt(0)
v_exp_f32 v175, v175
v_mfma_f32_16x16x32_bf16 a[160:163], v[140:143], v[192:195], a[160:163]
v_add_f32 v220, v220, v172
v_cvt_pk_bf16_f32 v188, v172, v173
v_mfma_f32_16x16x32_bf16 a[164:167], v[144:147], v[192:195], a[164:167]
v_exp_f32 v176, v176
v_mfma_f32_16x16x32_bf16 a[168:171], v[148:151], v[192:195], a[168:171]
v_add_f32 v220, v220, v173
v_add_f32 v220, v220, v174
v_mfma_f32_16x16x32_bf16 a[172:175], v[152:155], v[192:195], a[172:175]
v_exp_f32 v177, v177
v_mfma_f32_16x16x32_bf16 v[184:187], v[124:127], v[0:3], v[80:83]
v_add_f32 v220, v220, v175
v_cvt_pk_bf16_f32 v189, v174, v175
v_mfma_f32_16x16x32_bf16 v[184:187], v[128:131], v[4:7], v[184:187]
v_exp_f32 v178, v178
v_mfma_f32_16x16x32_bf16 v[184:187], v[132:135], v[8:11], v[184:187]
v_add_f32 v220, v220, v176
v_add_f32 v220, v220, v177
v_mfma_f32_16x16x32_bf16 v[184:187], v[136:139], v[12:15], v[184:187]
v_exp_f32 v179, v179
v_mfma_f32_16x16x32_bf16 a[176:179], v[156:159], v[192:195], a[176:179]
v_cvt_pk_bf16_f32 v190, v176, v177
v_add_f32 v220, v220, v178
v_mfma_f32_16x16x32_bf16 a[180:183], v[160:163], v[192:195], a[180:183]
v_cvt_pk_bf16_f32 v191, v178, v179
v_add_f32 v220, v220, v179
v_mfma_f32_16x16x32_bf16 a[184:187], v[164:167], v[192:195], a[184:187]
v_mfma_f32_16x16x32_bf16 a[188:191], v[168:171], v[192:195], a[188:191]
s_waitcnt vmcnt(2)
v_mfma_f32_16x16x32_bf16 v[172:175], v[108:111], v[16:19], v[84:87]
v_exp_f32 v180, v180
v_mfma_f32_16x16x32_bf16 v[172:175], v[112:115], v[20:23], v[172:175]
v_exp_f32 v181, v181
v_mfma_f32_16x16x32_bf16 v[172:175], v[116:119], v[24:27], v[172:175]
buffer_load_dword v251, v255, s[72:75], 0 offen
v_exp_f32 v182, v182
v_mfma_f32_16x16x32_bf16 v[172:175], v[120:123], v[28:31], v[172:175]
v_exp_f32 v183, v183
v_mfma_f32_16x16x32_bf16 a[192:195], v[140:143], v[188:191], a[192:195]
ds_read_b64_tr_b16 v[140:141], v200 offset:8192
ds_read_b64_tr_b16 v[142:143], v200 offset:12288
v_add_f32 v214, v214, v180
v_cvt_pk_bf16_f32 v192, v180, v181
v_mfma_f32_16x16x32_bf16 a[196:199], v[144:147], v[188:191], a[196:199]
ds_read_b64_tr_b16 v[144:145], v201 offset:8192
ds_read_b64_tr_b16 v[146:147], v201 offset:12288
v_exp_f32 v184, v184
v_mfma_f32_16x16x32_bf16 a[200:203], v[148:151], v[188:191], a[200:203]
ds_read_b64_tr_b16 v[148:149], v202 offset:8192
ds_read_b64_tr_b16 v[150:151], v202 offset:12288
v_add_f32 v214, v214, v181
v_add_f32 v214, v214, v182
v_mfma_f32_16x16x32_bf16 a[204:207], v[152:155], v[188:191], a[204:207]
ds_read_b64_tr_b16 v[152:153], v203 offset:8192
ds_read_b64_tr_b16 v[154:155], v203 offset:12288
v_exp_f32 v185, v185
v_mfma_f32_16x16x32_bf16 v[176:179], v[124:127], v[16:19], v[84:87]
v_add_f32 v214, v214, v183
v_cvt_pk_bf16_f32 v193, v182, v183
v_mfma_f32_16x16x32_bf16 v[176:179], v[128:131], v[20:23], v[176:179]
v_exp_f32 v186, v186
v_mfma_f32_16x16x32_bf16 v[176:179], v[132:135], v[24:27], v[176:179]
v_add_f32 v214, v214, v184
v_add_f32 v214, v214, v185
v_mfma_f32_16x16x32_bf16 v[176:179], v[136:139], v[28:31], v[176:179]
v_exp_f32 v187, v187
v_mfma_f32_16x16x32_bf16 a[208:211], v[156:159], v[188:191], a[208:211]
ds_read_b64_tr_b16 v[156:157], v204 offset:8192
ds_read_b64_tr_b16 v[158:159], v204 offset:12288
v_cvt_pk_bf16_f32 v194, v184, v185
v_add_f32 v214, v214, v186
v_mfma_f32_16x16x32_bf16 a[212:215], v[160:163], v[188:191], a[212:215]
ds_read_b64_tr_b16 v[160:161], v205 offset:8192
ds_read_b64_tr_b16 v[162:163], v205 offset:12288
v_cvt_pk_bf16_f32 v195, v186, v187
v_add_f32 v214, v214, v187
v_mfma_f32_16x16x32_bf16 a[216:219], v[164:167], v[188:191], a[216:219]
ds_read_b64_tr_b16 v[164:165], v206 offset:8192
ds_read_b64_tr_b16 v[166:167], v206 offset:12288
v_mfma_f32_16x16x32_bf16 a[220:223], v[168:171], v[188:191], a[220:223]
ds_read_b64_tr_b16 v[168:169], v207 offset:8192
ds_read_b64_tr_b16 v[170:171], v207 offset:12288
s_waitcnt lgkmcnt(8)
v_mfma_f32_16x16x32_bf16 v[180:183], v[108:111], v[32:35], v[88:91]
v_exp_f32 v172, v172
v_mfma_f32_16x16x32_bf16 v[180:183], v[112:115], v[36:39], v[180:183]
v_exp_f32 v173, v173
v_mfma_f32_16x16x32_bf16 v[180:183], v[116:119], v[40:43], v[180:183]
v_exp_f32 v174, v174
v_mfma_f32_16x16x32_bf16 v[180:183], v[120:123], v[44:47], v[180:183]
v_exp_f32 v175, v175
v_mfma_f32_16x16x32_bf16 a[0:3], v[140:143], v[192:195], a[0:3]
v_add_f32 v215, v215, v172
v_cvt_pk_bf16_f32 v188, v172, v173
v_mfma_f32_16x16x32_bf16 a[4:7], v[144:147], v[192:195], a[4:7]
v_exp_f32 v176, v176
v_mfma_f32_16x16x32_bf16 a[8:11], v[148:151], v[192:195], a[8:11]
v_add_f32 v215, v215, v173
v_add_f32 v215, v215, v174
v_mfma_f32_16x16x32_bf16 a[12:15], v[152:155], v[192:195], a[12:15]
s_waitcnt lgkmcnt(0)
v_exp_f32 v177, v177
v_mfma_f32_16x16x32_bf16 v[184:187], v[124:127], v[32:35], v[88:91]
v_add_f32 v215, v215, v175
v_cvt_pk_bf16_f32 v189, v174, v175
v_mfma_f32_16x16x32_bf16 v[184:187], v[128:131], v[36:39], v[184:187]
v_exp_f32 v178, v178
v_mfma_f32_16x16x32_bf16 v[184:187], v[132:135], v[40:43], v[184:187]
v_add_f32 v215, v215, v176
v_add_f32 v215, v215, v177
v_mfma_f32_16x16x32_bf16 v[184:187], v[136:139], v[44:47], v[184:187]
v_exp_f32 v179, v179
v_mfma_f32_16x16x32_bf16 a[16:19], v[156:159], v[192:195], a[16:19]
v_cvt_pk_bf16_f32 v190, v176, v177
v_add_f32 v215, v215, v178
v_mfma_f32_16x16x32_bf16 a[20:23], v[160:163], v[192:195], a[20:23]
v_cvt_pk_bf16_f32 v191, v178, v179
v_add_f32 v215, v215, v179
v_mfma_f32_16x16x32_bf16 a[24:27], v[164:167], v[192:195], a[24:27]
v_mfma_f32_16x16x32_bf16 a[28:31], v[168:171], v[192:195], a[28:31]
v_mfma_f32_16x16x32_bf16 v[172:175], v[108:111], v[48:51], v[92:95]
v_exp_f32 v180, v180
v_mfma_f32_16x16x32_bf16 v[172:175], v[112:115], v[52:55], v[172:175]
v_exp_f32 v181, v181
v_mfma_f32_16x16x32_bf16 v[172:175], v[116:119], v[56:59], v[172:175]
v_exp_f32 v182, v182
v_mfma_f32_16x16x32_bf16 v[172:175], v[120:123], v[60:63], v[172:175]
v_exp_f32 v183, v183
v_mfma_f32_16x16x32_bf16 a[32:35], v[140:143], v[188:191], a[32:35]
s_add_u32 s50, s71, 0
buffer_store_dwordx4 a[8:11], v252, s[40:43], s50 offen
v_add_f32 v216, v216, v180
v_cvt_pk_bf16_f32 v192, v180, v181
v_mfma_f32_16x16x32_bf16 a[36:39], v[144:147], v[188:191], a[36:39]
v_exp_f32 v184, v184
v_mfma_f32_16x16x32_bf16 a[40:43], v[148:151], v[188:191], a[40:43]
s_add_u32 s50, s71, 1024
buffer_store_dwordx4 a[12:15], v252, s[40:43], s50 offen
v_add_f32 v216, v216, v181
v_add_f32 v216, v216, v182
v_mfma_f32_16x16x32_bf16 a[44:47], v[152:155], v[188:191], a[44:47]
v_exp_f32 v185, v185
v_mfma_f32_16x16x32_bf16 v[176:179], v[124:127], v[48:51], v[92:95]
s_add_u32 s50, s71, 2048
buffer_store_dwordx4 a[16:19], v252, s[40:43], s50 offen
v_add_f32 v216, v216, v183
v_cvt_pk_bf16_f32 v193, v182, v183
v_mfma_f32_16x16x32_bf16 v[176:179], v[128:131], v[52:55], v[176:179]
v_exp_f32 v186, v186
v_mfma_f32_16x16x32_bf16 v[176:179], v[132:135], v[56:59], v[176:179]
s_add_u32 s50, s71, 3072
buffer_store_dwordx4 a[20:23], v252, s[40:43], s50 offen
v_add_f32 v216, v216, v184
v_add_f32 v216, v216, v185
v_mfma_f32_16x16x32_bf16 v[176:179], v[136:139], v[60:63], v[176:179]
v_exp_f32 v187, v187
v_mfma_f32_16x16x32_bf16 a[48:51], v[156:159], v[188:191], a[48:51]
s_add_u32 s50, s71, 4096
buffer_store_dwordx4 a[24:27], v252, s[40:43], s50 offen
v_cvt_pk_bf16_f32 v194, v184, v185
v_add_f32 v216, v216, v186
v_mfma_f32_16x16x32_bf16 a[52:55], v[160:163], v[188:191], a[52:55]
v_cvt_pk_bf16_f32 v195, v186, v187
v_add_f32 v216, v216, v187
v_mfma_f32_16x16x32_bf16 a[56:59], v[164:167], v[188:191], a[56:59]
s_add_u32 s50, s71, 5120
buffer_store_dwordx4 a[28:31], v252, s[40:43], s50 offen
v_mfma_f32_16x16x32_bf16 a[60:63], v[168:171], v[188:191], a[60:63]
v_mfma_f32_16x16x32_bf16 v[180:183], v[108:111], v[64:67], v[96:99]
v_exp_f32 v172, v172
v_mfma_f32_16x16x32_bf16 v[180:183], v[112:115], v[68:71], v[180:183]
v_exp_f32 v173, v173
v_mfma_f32_16x16x32_bf16 v[180:183], v[116:119], v[72:75], v[180:183]
v_exp_f32 v174, v174
v_mfma_f32_16x16x32_bf16 v[180:183], v[120:123], v[76:79], v[180:183]
v_exp_f32 v175, v175
v_mfma_f32_16x16x32_bf16 a[64:67], v[140:143], v[192:195], a[64:67]
ds_write_b128 v253, a[40:43] offset:0
v_add_f32 v217, v217, v172
v_cvt_pk_bf16_f32 v188, v172, v173
v_mfma_f32_16x16x32_bf16 a[68:71], v[144:147], v[192:195], a[68:71]
v_exp_f32 v176, v176
v_mfma_f32_16x16x32_bf16 a[72:75], v[148:151], v[192:195], a[72:75]
ds_write_b128 v253, a[44:47] offset:1024
v_add_f32 v217, v217, v173
v_add_f32 v217, v217, v174
v_mfma_f32_16x16x32_bf16 a[76:79], v[152:155], v[192:195], a[76:79]
v_exp_f32 v177, v177
v_mfma_f32_16x16x32_bf16 v[184:187], v[124:127], v[64:67], v[96:99]
ds_write_b128 v253, a[48:51] offset:2048
v_add_f32 v217, v217, v175
v_cvt_pk_bf16_f32 v189, v174, v175
v_mfma_f32_16x16x32_bf16 v[184:187], v[128:131], v[68:71], v[184:187]
v_exp_f32 v178, v178
v_mfma_f32_16x16x32_bf16 v[184:187], v[132:135], v[72:75], v[184:187]
ds_write_b128 v253, a[52:55] offset:3072
v_add_f32 v217, v217, v176
v_add_f32 v217, v217, v177
v_mfma_f32_16x16x32_bf16 v[184:187], v[136:139], v[76:79], v[184:187]
v_exp_f32 v179, v179
v_mfma_f32_16x16x32_bf16 a[80:83], v[156:159], v[192:195], a[80:83]
ds_write_b128 v253, a[56:59] offset:4096
v_cvt_pk_bf16_f32 v190, v176, v177
v_add_f32 v217, v217, v178
v_mfma_f32_16x16x32_bf16 a[84:87], v[160:163], v[192:195], a[84:87]
v_cvt_pk_bf16_f32 v191, v178, v179
v_add_f32 v217, v217, v179
v_mfma_f32_16x16x32_bf16 a[88:91], v[164:167], v[192:195], a[88:91]
ds_write_b128 v253, a[60:63] offset:5120
v_mfma_f32_16x16x32_bf16 a[92:95], v[168:171], v[192:195], a[92:95]
v_mfma_f32_16x16x32_bf16 v[172:175], v[108:111], a[224:227], v[100:103]
v_exp_f32 v180, v180
v_mfma_f32_16x16x32_bf16 v[172:175], v[112:115], a[228:231], v[172:175]
v_exp_f32 v181, v181
v_mfma_f32_16x16x32_bf16 v[172:175], v[116:119], a[232:235], v[172:175]
v_exp_f32 v182, v182
v_mfma_f32_16x16x32_bf16 v[172:175], v[120:123], a[236:239], v[172:175]
v_exp_f32 v183, v183
v_mfma_f32_16x16x32_bf16 a[96:99], v[140:143], v[188:191], a[96:99]
ds_write_b128 v253, a[72:75] offset:6144
v_add_f32 v218, v218, v180
v_cvt_pk_bf16_f32 v192, v180, v181
v_mfma_f32_16x16x32_bf16 a[100:103], v[144:147], v[188:191], a[100:103]
v_exp_f32 v184, v184
v_mfma_f32_16x16x32_bf16 a[104:107], v[148:151], v[188:191], a[104:107]
ds_write_b128 v253, a[76:79] offset:7168
v_add_f32 v218, v218, v181
v_add_f32 v218, v218, v182
v_mfma_f32_16x16x32_bf16 a[108:111], v[152:155], v[188:191], a[108:111]
v_exp_f32 v185, v185
v_mfma_f32_16x16x32_bf16 v[176:179], v[124:127], a[224:227], v[100:103]
ds_write_b128 v253, a[80:83] offset:8192
v_add_f32 v218, v218, v183
v_cvt_pk_bf16_f32 v193, v182, v183
v_mfma_f32_16x16x32_bf16 v[176:179], v[128:131], a[228:231], v[176:179]
v_exp_f32 v186, v186
v_mfma_f32_16x16x32_bf16 v[176:179], v[132:135], a[232:235], v[176:179]
ds_write_b128 v253, a[84:87] offset:9216
v_add_f32 v218, v218, v184
v_add_f32 v218, v218, v185
v_mfma_f32_16x16x32_bf16 v[176:179], v[136:139], a[236:239], v[176:179]
v_exp_f32 v187, v187
v_mfma_f32_16x16x32_bf16 a[112:115], v[156:159], v[188:191], a[112:115]
ds_write_b128 v253, a[88:91] offset:10240
v_cvt_pk_bf16_f32 v194, v184, v185
v_add_f32 v218, v218, v186
v_mfma_f32_16x16x32_bf16 a[116:119], v[160:163], v[188:191], a[116:119]
v_cvt_pk_bf16_f32 v195, v186, v187
v_add_f32 v218, v218, v187
v_mfma_f32_16x16x32_bf16 a[120:123], v[164:167], v[188:191], a[120:123]
ds_write_b128 v253, a[92:95] offset:11264
v_mfma_f32_16x16x32_bf16 a[124:127], v[168:171], v[188:191], a[124:127]
v_mfma_f32_16x16x32_bf16 v[180:183], v[108:111], a[240:243], v[104:107]
v_exp_f32 v172, v172
v_mfma_f32_16x16x32_bf16 v[180:183], v[112:115], a[244:247], v[180:183]
v_exp_f32 v173, v173
v_mfma_f32_16x16x32_bf16 v[180:183], v[116:119], a[248:251], v[180:183]
v_exp_f32 v174, v174
v_mfma_f32_16x16x32_bf16 v[180:183], v[120:123], a[252:255], v[180:183]
v_exp_f32 v175, v175
v_mfma_f32_16x16x32_bf16 a[128:131], v[140:143], v[192:195], a[128:131]
ds_write_b128 v253, a[104:107] offset:12288
v_add_f32 v219, v219, v172
v_cvt_pk_bf16_f32 v188, v172, v173
v_mfma_f32_16x16x32_bf16 a[132:135], v[144:147], v[192:195], a[132:135]
v_exp_f32 v176, v176
v_mfma_f32_16x16x32_bf16 a[136:139], v[148:151], v[192:195], a[136:139]
ds_write_b128 v253, a[108:111] offset:13312
v_add_f32 v219, v219, v173
v_add_f32 v219, v219, v174
v_mfma_f32_16x16x32_bf16 a[140:143], v[152:155], v[192:195], a[140:143]
v_exp_f32 v177, v177
v_mfma_f32_16x16x32_bf16 v[184:187], v[124:127], a[240:243], v[104:107]
ds_write_b128 v253, a[112:115] offset:14336
v_add_f32 v219, v219, v175
v_cvt_pk_bf16_f32 v189, v174, v175
v_mfma_f32_16x16x32_bf16 v[184:187], v[128:131], a[244:247], v[184:187]
v_exp_f32 v178, v178
v_mfma_f32_16x16x32_bf16 v[184:187], v[132:135], a[248:251], v[184:187]
ds_write_b128 v253, a[116:119] offset:15360
v_add_f32 v219, v219, v176
v_add_f32 v219, v219, v177
v_mfma_f32_16x16x32_bf16 v[184:187], v[136:139], a[252:255], v[184:187]
v_exp_f32 v179, v179
v_mfma_f32_16x16x32_bf16 a[144:147], v[156:159], v[192:195], a[144:147]
ds_write_b128 v253, a[120:123] offset:16384
v_cvt_pk_bf16_f32 v190, v176, v177
v_add_f32 v219, v219, v178
v_mfma_f32_16x16x32_bf16 a[148:151], v[160:163], v[192:195], a[148:151]
v_cvt_pk_bf16_f32 v191, v178, v179
v_add_f32 v219, v219, v179
v_mfma_f32_16x16x32_bf16 a[152:155], v[164:167], v[192:195], a[152:155]
ds_write_b128 v253, a[124:127] offset:17408
v_mfma_f32_16x16x32_bf16 a[156:159], v[168:171], v[192:195], a[156:159]
v_mfma_f32_16x16x32_bf16 a[160:163], v[140:143], v[188:191], a[160:163]
v_exp_f32 v180, v180
v_exp_f32 v181, v181
v_exp_f32 v182, v182
v_mfma_f32_16x16x32_bf16 a[164:167], v[144:147], v[188:191], a[164:167]
v_add_f32 v220, v220, v180
v_exp_f32 v183, v183
v_mfma_f32_16x16x32_bf16 a[168:171], v[148:151], v[188:191], a[168:171]
v_add_f32 v220, v220, v181
v_cvt_pk_bf16_f32 v192, v180, v181
v_exp_f32 v184, v184
ds_write_b128 v253, a[136:139] offset:18432
v_mfma_f32_16x16x32_bf16 a[172:175], v[152:155], v[188:191], a[172:175]
v_add_f32 v220, v220, v182
v_exp_f32 v185, v185
ds_write_b128 v253, a[140:143] offset:19456
v_mfma_f32_16x16x32_bf16 a[176:179], v[156:159], v[188:191], a[176:179]
v_add_f32 v220, v220, v183
v_cvt_pk_bf16_f32 v193, v182, v183
v_exp_f32 v186, v186
ds_write_b128 v253, a[144:147] offset:20480
v_mfma_f32_16x16x32_bf16 a[180:183], v[160:163], v[188:191], a[180:183]
v_add_f32 v220, v220, v184
v_exp_f32 v187, v187
ds_write_b128 v253, a[148:151] offset:21504
v_mfma_f32_16x16x32_bf16 a[184:187], v[164:167], v[188:191], a[184:187]
v_add_f32 v220, v220, v185
v_cvt_pk_bf16_f32 v194, v184, v185
v_add_f32 v220, v220, v186
ds_write_b128 v253, a[152:155] offset:22528
v_mfma_f32_16x16x32_bf16 a[188:191], v[168:171], v[188:191], a[188:191]
v_cvt_pk_bf16_f32 v195, v186, v187
v_add_f32 v220, v220, v187
ds_write_b128 v253, a[156:159] offset:23552
s_nop 1
v_mfma_f32_16x16x32_bf16 a[192:195], v[140:143], v[192:195], a[192:195]
v_mov_b32 v232, v214
v_mov_b32 v233, v215
v_mov_b32 v234, v216
v_mov_b32 v235, v217
v_mov_b32 v236, v218
v_mov_b32 v237, v219
v_mov_b32 v238, v220
s_nop 1
v_mfma_f32_16x16x32_bf16 a[196:199], v[144:147], v[192:195], a[196:199]
v_permlane32_swap_b32 v214, v232
v_permlane32_swap_b32 v215, v233
v_permlane32_swap_b32 v216, v234
v_permlane32_swap_b32 v217, v235
v_permlane32_swap_b32 v218, v236
v_permlane32_swap_b32 v219, v237
v_permlane32_swap_b32 v220, v238
v_mfma_f32_16x16x32_bf16 a[200:203], v[148:151], v[192:195], a[200:203]
s_nop 1
v_add_f32 v214, v214, v232
v_add_f32 v215, v215, v233
v_add_f32 v216, v216, v234
v_add_f32 v217, v217, v235
v_add_f32 v218, v218, v236
v_add_f32 v219, v219, v237
ds_write_b128 v253, a[168:171] offset:24576
v_mfma_f32_16x16x32_bf16 a[204:207], v[152:155], v[192:195], a[204:207]
v_add_f32 v220, v220, v238
v_mov_b32 v232, v214
v_mov_b32 v233, v215
v_mov_b32 v234, v216
v_mov_b32 v235, v217
v_mov_b32 v236, v218
v_mov_b32 v237, v219
ds_write_b128 v253, a[172:175] offset:25600
v_mfma_f32_16x16x32_bf16 a[208:211], v[156:159], v[192:195], a[208:211]
v_mov_b32 v238, v220
s_nop 1
v_permlane16_swap_b32 v214, v232
v_permlane16_swap_b32 v215, v233
v_permlane16_swap_b32 v216, v234
v_permlane16_swap_b32 v217, v235
v_permlane16_swap_b32 v218, v236
v_permlane16_swap_b32 v219, v237
ds_write_b128 v253, a[176:179] offset:26624
v_mfma_f32_16x16x32_bf16 a[212:215], v[160:163], v[192:195], a[212:215]
v_permlane16_swap_b32 v220, v238
s_nop 1
v_add_f32 v214, v214, v232
v_add_f32 v215, v215, v233
v_add_f32 v216, v216, v234
v_add_f32 v217, v217, v235
v_add_f32 v218, v218, v236
ds_write_b128 v253, a[180:183] offset:27648
v_mfma_f32_16x16x32_bf16 a[216:219], v[164:167], v[192:195], a[216:219]
v_add_f32 v219, v219, v237
v_add_f32 v220, v220, v238
v_lshlrev_b32 v254, 4, v223
v_add_u32 v255, 40960, v254
s_lshl_b32 s47, s44, 2
v_add_u32 v241, s47, v254
v_add_u32 v245, 40960, v241
ds_write_b128 v253, a[184:187] offset:28672
v_mfma_f32_16x16x32_bf16 a[220:223], v[168:171], v[192:195], a[220:223]
ds_write_b32 v241, v214 offset:39936
ds_write_b32 v241, v215 offset:40192
ds_write_b32 v241, v216 offset:40448
ds_write_b32 v241, v217 offset:40704
ds_write_b32 v245, v218 offset:39936
ds_write_b32 v245, v219 offset:40192
ds_write_b32 v245, v220 offset:40448
ds_write_b128 v253, a[188:191] offset:29696
ds_write_b128 v253, a[200:203] offset:30720
ds_write_b128 v253, a[204:207] offset:31744
ds_write_b128 v253, a[208:211] offset:32768
ds_write_b128 v253, a[212:215] offset:33792
ds_write_b128 v253, a[216:219] offset:34816
ds_write_b128 v253, a[220:223] offset:35840
v_accvgpr_read_b32 v108, a0
v_accvgpr_read_b32 v109, a1
v_accvgpr_read_b32 v110, a2
v_accvgpr_read_b32 v111, a3
v_accvgpr_read_b32 v112, a4
v_accvgpr_read_b32 v113, a5
v_accvgpr_read_b32 v114, a6
v_accvgpr_read_b32 v115, a7
v_accvgpr_read_b32 v116, a32
v_accvgpr_read_b32 v117, a33
v_accvgpr_read_b32 v118, a34
v_accvgpr_read_b32 v119, a35
v_accvgpr_read_b32 v120, a36
v_accvgpr_read_b32 v121, a37
v_accvgpr_read_b32 v122, a38
v_accvgpr_read_b32 v123, a39
v_accvgpr_read_b32 v124, a64
v_accvgpr_read_b32 v125, a65
v_accvgpr_read_b32 v126, a66
v_accvgpr_read_b32 v127, a67
v_accvgpr_read_b32 v128, a68
v_accvgpr_read_b32 v129, a69
v_accvgpr_read_b32 v130, a70
v_accvgpr_read_b32 v131, a71
v_accvgpr_read_b32 v132, a96
v_accvgpr_read_b32 v133, a97
v_accvgpr_read_b32 v134, a98
v_accvgpr_read_b32 v135, a99
v_accvgpr_read_b32 v136, a100
v_accvgpr_read_b32 v137, a101
v_accvgpr_read_b32 v138, a102
v_accvgpr_read_b32 v139, a103
v_accvgpr_read_b32 v140, a128
v_accvgpr_read_b32 v141, a129
v_accvgpr_read_b32 v142, a130
v_accvgpr_read_b32 v143, a131
v_accvgpr_read_b32 v144, a132
v_accvgpr_read_b32 v145, a133
v_accvgpr_read_b32 v146, a134
v_accvgpr_read_b32 v147, a135
v_accvgpr_read_b32 v148, a160
v_accvgpr_read_b32 v149, a161
v_accvgpr_read_b32 v150, a162
v_accvgpr_read_b32 v151, a163
v_accvgpr_read_b32 v152, a164
v_accvgpr_read_b32 v153, a165
v_accvgpr_read_b32 v154, a166
v_accvgpr_read_b32 v155, a167
v_accvgpr_read_b32 v156, a192
v_accvgpr_read_b32 v157, a193
v_accvgpr_read_b32 v158, a194
v_accvgpr_read_b32 v159, a195
v_accvgpr_read_b32 v160, a196
v_accvgpr_read_b32 v161, a197
v_accvgpr_read_b32 v162, a198
v_accvgpr_read_b32 v163, a199
s_add_u32 s47, s44, 1
s_and_b32 s47, s47, 3
s_mul_i32 s72, s47, 6144
s_mul_i32 s47, s47, 40960
v_add_u32 v200, s47, v252
s_add_u32 s47, s44, 2
s_and_b32 s47, s47, 3
s_mul_i32 s73, s47, 6144
s_mul_i32 s47, s47, 40960
v_add_u32 v201, s47, v252
s_add_u32 s47, s44, 3
s_and_b32 s47, s47, 3
s_mul_i32 s74, s47, 6144
s_mul_i32 s47, s47, 40960
v_add_u32 v202, s47, v252
v_and_b32 v212, 7, v221
v_and_b32 v213, 1, v212
v_lshrrev_b32 v212, 1, v212
v_xor_b32 v212, v212, v222
v_lshlrev_b32 v212, 5, v212
v_lshlrev_b32 v213, 4, v213
v_add_u32 v212, v212, v213
v_lshrrev_b32 v213, 3, v221
v_mul_u32_u24 v213, 1152, v213
v_add_u32 v212, v212, v213
s_mul_i32 s47, s44, 1179648
v_add_u32 v204, s47, v212
v_add_u32 v205, 8192, v204
v_add_u32 v206, 16384, v204
v_add_u32 v207, 24576, v204
s_waitcnt vmcnt(0) lgkmcnt(0)
s_barrier
s_add_u32 s50, s72, 4096
buffer_load_dwordx4 v[224:227], v252, s[40:43], s50 offen sc0
s_add_u32 s50, s72, 5120
buffer_load_dwordx4 v[228:231], v252, s[40:43], s50 offen sc0
s_add_u32 s50, s73, 2048
buffer_load_dwordx4 v[232:235], v252, s[40:43], s50 offen sc0
s_add_u32 s50, s73, 3072
buffer_load_dwordx4 v[236:239], v252, s[40:43], s50 offen sc0
s_add_u32 s50, s74, 0
buffer_load_dwordx4 v[240:243], v252, s[40:43], s50 offen sc0
s_add_u32 s50, s74, 1024
buffer_load_dwordx4 v[244:247], v252, s[40:43], s50 offen sc0
ds_read_b128 v[164:167], v254 offset:39936
ds_read_b128 v[168:171], v254 offset:40192
ds_read_b128 v[172:175], v254 offset:40448
ds_read_b128 v[176:179], v254 offset:40704
ds_read_b128 v[180:183], v255 offset:39936
ds_read_b128 v[184:187], v255 offset:40192
ds_read_b128 v[188:191], v255 offset:40448
ds_read_b128 v[0:3], v200 offset:4096
ds_read_b128 v[4:7], v200 offset:5120
ds_read_b128 v[8:11], v201 offset:2048
ds_read_b128 v[12:15], v201 offset:3072
ds_read_b128 v[16:19], v202 offset:0
ds_read_b128 v[20:23], v202 offset:1024
ds_read_b128 v[24:27], v200 offset:10240
ds_read_b128 v[28:31], v200 offset:11264
s_waitcnt lgkmcnt(8)
v_pk_add_f32 v[164:165], v[164:165], v[166:167]
v_pk_add_f32 v[168:169], v[168:169], v[170:171]
v_pk_add_f32 v[172:173], v[172:173], v[174:175]
v_pk_add_f32 v[176:177], v[176:177], v[178:179]
v_pk_add_f32 v[180:181], v[180:181], v[182:183]
v_pk_add_f32 v[184:185], v[184:185], v[186:187]
v_pk_add_f32 v[188:189], v[188:189], v[190:191]
v_add_f32 v214, v164, v165
v_add_f32 v215, v168, v169
v_add_f32 v216, v172, v173
v_add_f32 v217, v176, v177
v_add_f32 v218, v180, v181
v_add_f32 v219, v184, v185
v_add_f32 v220, v188, v189
ds_read_b128 v[32:35], v201 offset:8192
ds_read_b128 v[36:39], v201 offset:9216
ds_read_b128 v[40:43], v202 offset:6144
ds_read_b128 v[44:47], v202 offset:7168
ds_read_b128 v[48:51], v200 offset:16384
ds_read_b128 v[52:55], v200 offset:17408
ds_read_b128 v[56:59], v201 offset:14336
ds_read_b128 v[60:63], v201 offset:15360
ds_read_b128 v[64:67], v202 offset:12288
ds_read_b128 v[68:71], v202 offset:13312
ds_read_b128 v[72:75], v200 offset:22528
ds_read_b128 v[76:79], v200 offset:23552
ds_read_b128 v[80:83], v201 offset:20480
ds_read_b128 v[84:87], v201 offset:21504
ds_read_b128 v[88:91], v202 offset:18432
ds_read_b128 v[92:95], v202 offset:19456
ds_read_b128 v[96:99], v200 offset:28672
ds_read_b128 v[100:103], v200 offset:29696
ds_read_b128 v[104:107], v201 offset:26624
ds_read_b128 v[164:167], v201 offset:27648
ds_read_b128 v[168:171], v202 offset:24576
ds_read_b128 v[172:175], v202 offset:25600
ds_read_b128 v[176:179], v200 offset:34816
ds_read_b128 v[180:183], v200 offset:35840
ds_read_b128 v[184:187], v201 offset:32768
ds_read_b128 v[188:191], v201 offset:33792
ds_read_b128 v[192:195], v202 offset:30720
ds_read_b128 v[196:199], v202 offset:31744
v_mov_b32 v203, s61
v_cmp_nle_f32 vcc, v214, v203
v_cmp_nle_f32 s[68:69], v215, v203
s_nop 1
s_or_b64 vcc, vcc, s[68:69]
v_cmp_nle_f32 s[68:69], v216, v203
s_nop 1
s_or_b64 vcc, vcc, s[68:69]
v_cmp_nle_f32 s[68:69], v217, v203
s_nop 1
s_or_b64 vcc, vcc, s[68:69]
v_cmp_nle_f32 s[68:69], v218, v203
s_nop 1
s_or_b64 vcc, vcc, s[68:69]
v_cmp_nle_f32 s[68:69], v219, v203
s_nop 1
s_or_b64 vcc, vcc, s[68:69]
v_cmp_nle_f32 s[68:69], v220, v203
s_nop 1
s_or_b64 vcc, vcc, s[68:69]
s_cmp_lg_u32 s60, 0
s_cbranch_scc1 L_nofb
s_cmp_lg_u64 vcc, 0
s_cbranch_scc1 L_fallback
L_nofb:
v_rcp_f32 v214, v214
v_rcp_f32 v215, v215
v_rcp_f32 v216, v216
v_rcp_f32 v217, v217
v_rcp_f32 v218, v218
v_rcp_f32 v219, v219
v_rcp_f32 v220, v220
s_waitcnt lgkmcnt(15)
v_pk_add_f32 v[116:117], v[116:117], v[0:1]
v_pk_add_f32 v[118:119], v[118:119], v[2:3]
v_pk_add_f32 v[116:117], v[116:117], v[8:9]
v_pk_add_f32 v[118:119], v[118:119], v[10:11]
v_pk_add_f32 v[116:117], v[116:117], v[16:17]
v_pk_add_f32 v[118:119], v[118:119], v[18:19]
v_pk_add_f32 v[120:121], v[120:121], v[4:5]
v_pk_add_f32 v[122:123], v[122:123], v[6:7]
v_pk_add_f32 v[120:121], v[120:121], v[12:13]
v_pk_add_f32 v[122:123], v[122:123], v[14:15]
v_pk_add_f32 v[120:121], v[120:121], v[20:21]
v_pk_add_f32 v[122:123], v[122:123], v[22:23]
v_pk_mul_f32 v[116:117], v[116:117], v[214:215] op_sel:[0,1] op_sel_hi:[1,1]
v_pk_mul_f32 v[118:119], v[118:119], v[214:215] op_sel:[0,1] op_sel_hi:[1,1]
v_pk_mul_f32 v[120:121], v[120:121], v[214:215] op_sel:[0,1] op_sel_hi:[1,1]
v_pk_mul_f32 v[122:123], v[122:123], v[214:215] op_sel:[0,1] op_sel_hi:[1,1]
v_cvt_pk_bf16_f32 v116, v116, v117
v_cvt_pk_bf16_f32 v117, v118, v119
v_cvt_pk_bf16_f32 v118, v120, v121
v_cvt_pk_bf16_f32 v119, v122, v123
s_mov_b32 s48, 131072
buffer_store_dwordx4 v[116:119], v252, s[36:39], s48 offen sc0 sc1
v_pk_add_f32 v[124:125], v[124:125], v[24:25]
v_pk_add_f32 v[126:127], v[126:127], v[26:27]
v_pk_add_f32 v[124:125], v[124:125], v[32:33]
v_pk_add_f32 v[126:127], v[126:127], v[34:35]
v_pk_add_f32 v[124:125], v[124:125], v[40:41]
v_pk_add_f32 v[126:127], v[126:127], v[42:43]
v_pk_add_f32 v[128:129], v[128:129], v[28:29]
v_pk_add_f32 v[130:131], v[130:131], v[30:31]
v_pk_add_f32 v[128:129], v[128:129], v[36:37]
v_pk_add_f32 v[130:131], v[130:131], v[38:39]
v_pk_add_f32 v[128:129], v[128:129], v[44:45]
v_pk_add_f32 v[130:131], v[130:131], v[46:47]
v_pk_mul_f32 v[124:125], v[124:125], v[216:217] op_sel_hi:[1,0]
v_pk_mul_f32 v[126:127], v[126:127], v[216:217] op_sel_hi:[1,0]
v_pk_mul_f32 v[128:129], v[128:129], v[216:217] op_sel_hi:[1,0]
v_pk_mul_f32 v[130:131], v[130:131], v[216:217] op_sel_hi:[1,0]
v_cvt_pk_bf16_f32 v124, v124, v125
v_cvt_pk_bf16_f32 v125, v126, v127
v_cvt_pk_bf16_f32 v126, v128, v129
v_cvt_pk_bf16_f32 v127, v130, v131
s_mov_b32 s48, 262144
buffer_store_dwordx4 v[124:127], v252, s[36:39], s48 offen sc0 sc1
v_pk_add_f32 v[132:133], v[132:133], v[48:49]
v_pk_add_f32 v[134:135], v[134:135], v[50:51]
v_pk_add_f32 v[132:133], v[132:133], v[56:57]
v_pk_add_f32 v[134:135], v[134:135], v[58:59]
v_pk_add_f32 v[132:133], v[132:133], v[64:65]
v_pk_add_f32 v[134:135], v[134:135], v[66:67]
v_pk_add_f32 v[136:137], v[136:137], v[52:53]
v_pk_add_f32 v[138:139], v[138:139], v[54:55]
v_pk_add_f32 v[136:137], v[136:137], v[60:61]
v_pk_add_f32 v[138:139], v[138:139], v[62:63]
v_pk_add_f32 v[136:137], v[136:137], v[68:69]
v_pk_add_f32 v[138:139], v[138:139], v[70:71]
v_pk_mul_f32 v[132:133], v[132:133], v[216:217] op_sel:[0,1] op_sel_hi:[1,1]
v_pk_mul_f32 v[134:135], v[134:135], v[216:217] op_sel:[0,1] op_sel_hi:[1,1]
v_pk_mul_f32 v[136:137], v[136:137], v[216:217] op_sel:[0,1] op_sel_hi:[1,1]
v_pk_mul_f32 v[138:139], v[138:139], v[216:217] op_sel:[0,1] op_sel_hi:[1,1]
v_cvt_pk_bf16_f32 v132, v132, v133
v_cvt_pk_bf16_f32 v133, v134, v135
v_cvt_pk_bf16_f32 v134, v136, v137
v_cvt_pk_bf16_f32 v135, v138, v139
s_mov_b32 s48, 393216
buffer_store_dwordx4 v[132:135], v252, s[36:39], s48 offen sc0 sc1
s_waitcnt lgkmcnt(0)
s_barrier
s_add_u32 s64, s67, 0
s_and_b32 s64, s64, 31
s_mul_i32 s66, s64, 36864
s_add_u32 m0, s51, 0
s_nop 0
buffer_load_dwordx4 v204, s[24:27], s66 offen  lds
v_pk_add_f32 v[140:141], v[140:141], v[72:73]
v_pk_add_f32 v[142:143], v[142:143], v[74:75]
v_pk_add_f32 v[140:141], v[140:141], v[80:81]
v_pk_add_f32 v[142:143], v[142:143], v[82:83]
buffer_load_dwordx4 v205, s[24:27], s66 offen offset:1024  lds
v_pk_add_f32 v[140:141], v[140:141], v[88:89]
v_pk_add_f32 v[142:143], v[142:143], v[90:91]
v_pk_add_f32 v[144:145], v[144:145], v[76:77]
v_pk_add_f32 v[146:147], v[146:147], v[78:79]
buffer_load_dwordx4 v206, s[24:27], s66 offen offset:2048  lds
v_pk_add_f32 v[144:145], v[144:145], v[84:85]
v_pk_add_f32 v[146:147], v[146:147], v[86:87]
v_pk_add_f32 v[144:145], v[144:145], v[92:93]
v_pk_add_f32 v[146:147], v[146:147], v[94:95]
buffer_load_dwordx4 v207, s[24:27], s66 offen offset:3072  lds
v_pk_mul_f32 v[140:141], v[140:141], v[218:219] op_sel_hi:[1,0]
v_pk_mul_f32 v[142:143], v[142:143], v[218:219] op_sel_hi:[1,0]
v_pk_mul_f32 v[144:145], v[144:145], v[218:219] op_sel_hi:[1,0]
v_pk_mul_f32 v[146:147], v[146:147], v[218:219] op_sel_hi:[1,0]
s_add_u32 s64, s67, 1
s_and_b32 s64, s64, 31
s_mul_i32 s66, s64, 36864
s_add_u32 m0, s51, 4096
s_nop 0
buffer_load_dwordx4 v204, s[24:27], s66 offen  lds
v_cvt_pk_bf16_f32 v140, v140, v141
v_cvt_pk_bf16_f32 v141, v142, v143
v_cvt_pk_bf16_f32 v142, v144, v145
v_cvt_pk_bf16_f32 v143, v146, v147
buffer_load_dwordx4 v205, s[24:27], s66 offen offset:1024  lds
s_mov_b32 s48, 524288
buffer_store_dwordx4 v[140:143], v252, s[36:39], s48 offen sc0 sc1
v_pk_add_f32 v[148:149], v[148:149], v[96:97]
v_pk_add_f32 v[150:151], v[150:151], v[98:99]
v_pk_add_f32 v[148:149], v[148:149], v[104:105]
v_pk_add_f32 v[150:151], v[150:151], v[106:107]
buffer_load_dwordx4 v206, s[24:27], s66 offen offset:2048  lds
v_pk_add_f32 v[148:149], v[148:149], v[168:169]
v_pk_add_f32 v[150:151], v[150:151], v[170:171]
v_pk_add_f32 v[152:153], v[152:153], v[100:101]
v_pk_add_f32 v[154:155], v[154:155], v[102:103]
buffer_load_dwordx4 v207, s[24:27], s66 offen offset:3072  lds
v_pk_add_f32 v[152:153], v[152:153], v[164:165]
v_pk_add_f32 v[154:155], v[154:155], v[166:167]
v_pk_add_f32 v[152:153], v[152:153], v[172:173]
v_pk_add_f32 v[154:155], v[154:155], v[174:175]
s_add_u32 s64, s67, 2
s_and_b32 s64, s64, 31
s_mul_i32 s66, s64, 36864
s_add_u32 m0, s51, 8192
s_nop 0
buffer_load_dwordx4 v204, s[24:27], s66 offen  lds
v_pk_mul_f32 v[148:149], v[148:149], v[218:219] op_sel:[0,1] op_sel_hi:[1,1]
v_pk_mul_f32 v[150:151], v[150:151], v[218:219] op_sel:[0,1] op_sel_hi:[1,1]
v_pk_mul_f32 v[152:153], v[152:153], v[218:219] op_sel:[0,1] op_sel_hi:[1,1]
v_pk_mul_f32 v[154:155], v[154:155], v[218:219] op_sel:[0,1] op_sel_hi:[1,1]
buffer_load_dwordx4 v205, s[24:27], s66 offen offset:1024  lds
v_cvt_pk_bf16_f32 v148, v148, v149
v_cvt_pk_bf16_f32 v149, v150, v151
v_cvt_pk_bf16_f32 v150, v152, v153
v_cvt_pk_bf16_f32 v151, v154, v155
buffer_load_dwordx4 v206, s[24:27], s66 offen offset:2048  lds
s_mov_b32 s48, 655360
buffer_store_dwordx4 v[148:151], v252, s[36:39], s48 offen sc0 sc1
v_pk_add_f32 v[156:157], v[156:157], v[176:177]
v_pk_add_f32 v[158:159], v[158:159], v[178:179]
v_pk_add_f32 v[156:157], v[156:157], v[184:185]
v_pk_add_f32 v[158:159], v[158:159], v[186:187]
buffer_load_dwordx4 v207, s[24:27], s66 offen offset:3072  lds
v_pk_add_f32 v[156:157], v[156:157], v[192:193]
v_pk_add_f32 v[158:159], v[158:159], v[194:195]
v_pk_add_f32 v[160:161], v[160:161], v[180:181]
v_pk_add_f32 v[162:163], v[162:163], v[182:183]
s_add_u32 s64, s67, 3
s_and_b32 s64, s64, 31
s_mul_i32 s66, s64, 36864
s_add_u32 m0, s51, 12288
s_nop 0
buffer_load_dwordx4 v204, s[24:27], s66 offen  lds
v_pk_add_f32 v[160:161], v[160:161], v[188:189]
v_pk_add_f32 v[162:163], v[162:163], v[190:191]
v_pk_add_f32 v[160:161], v[160:161], v[196:197]
v_pk_add_f32 v[162:163], v[162:163], v[198:199]
buffer_load_dwordx4 v205, s[24:27], s66 offen offset:1024  lds
v_pk_mul_f32 v[156:157], v[156:157], v[220:221] op_sel_hi:[1,0]
v_pk_mul_f32 v[158:159], v[158:159], v[220:221] op_sel_hi:[1,0]
v_pk_mul_f32 v[160:161], v[160:161], v[220:221] op_sel_hi:[1,0]
v_pk_mul_f32 v[162:163], v[162:163], v[220:221] op_sel_hi:[1,0]
buffer_load_dwordx4 v206, s[24:27], s66 offen offset:2048  lds
v_cvt_pk_bf16_f32 v156, v156, v157
v_cvt_pk_bf16_f32 v157, v158, v159
v_cvt_pk_bf16_f32 v158, v160, v161
v_cvt_pk_bf16_f32 v159, v162, v163
buffer_load_dwordx4 v207, s[24:27], s66 offen offset:3072  lds
s_mov_b32 s48, 786432
buffer_store_dwordx4 v[156:159], v252, s[36:39], s48 offen sc0 sc1
s_waitcnt vmcnt(22)
v_pk_add_f32 v[108:109], v[108:109], v[224:225]
v_pk_add_f32 v[110:111], v[110:111], v[226:227]
v_pk_add_f32 v[108:109], v[108:109], v[232:233]
v_pk_add_f32 v[110:111], v[110:111], v[234:235]
s_add_u32 s64, s67, 4
s_and_b32 s64, s64, 31
s_mul_i32 s66, s64, 36864
s_add_u32 m0, s51, 16384
s_nop 0
buffer_load_dwordx4 v204, s[24:27], s66 offen  lds
v_pk_add_f32 v[108:109], v[108:109], v[240:241]
v_pk_add_f32 v[110:111], v[110:111], v[242:243]
v_pk_add_f32 v[112:113], v[112:113], v[228:229]
v_pk_add_f32 v[114:115], v[114:115], v[230:231]
buffer_load_dwordx4 v205, s[24:27], s66 offen offset:1024  lds
v_pk_add_f32 v[112:113], v[112:113], v[236:237]
v_pk_add_f32 v[114:115], v[114:115], v[238:239]
v_pk_add_f32 v[112:113], v[112:113], v[244:245]
v_pk_add_f32 v[114:115], v[114:115], v[246:247]
buffer_load_dwordx4 v206, s[24:27], s66 offen offset:2048  lds
v_pk_mul_f32 v[108:109], v[108:109], v[214:215] op_sel_hi:[1,0]
v_pk_mul_f32 v[110:111], v[110:111], v[214:215] op_sel_hi:[1,0]
v_pk_mul_f32 v[112:113], v[112:113], v[214:215] op_sel_hi:[1,0]
v_pk_mul_f32 v[114:115], v[114:115], v[214:215] op_sel_hi:[1,0]
buffer_load_dwordx4 v207, s[24:27], s66 offen offset:3072  lds
v_cvt_pk_bf16_f32 v108, v108, v109
v_cvt_pk_bf16_f32 v109, v110, v111
v_cvt_pk_bf16_f32 v110, v112, v113
v_cvt_pk_bf16_f32 v111, v114, v115
s_add_u32 s64, s67, 5
s_and_b32 s64, s64, 31
s_mul_i32 s66, s64, 36864
s_add_u32 m0, s51, 20480
s_nop 0
buffer_load_dwordx4 v204, s[24:27], s66 offen  lds
s_mov_b32 s48, 0
buffer_store_dwordx4 v[108:111], v252, s[36:39], s48 offen sc0 sc1
s_lshl_b32 s47, s44, 15
v_add_u32 v116, s47, v252
v_lshrrev_b32 v6, 2, v223
v_lshlrev_b32 v7, 2, v222
v_add_u32 v7, v7, v6
v_lshrrev_b32 v8, 1, v7
v_and_b32 v8, 3, v8
v_lshlrev_b32 v8, 5, v8
buffer_load_dwordx4 v205, s[24:27], s66 offen offset:1024  lds
v_lshlrev_b32 v7, 7, v7
v_and_b32 v9, 3, v223
v_lshlrev_b32 v9, 3, v9
v_add_u32 v7, v7, v9
v_add_u32 v7, s51, v7
v_xor_b32 v9, 0, v8
v_add_u32 v112, v7, v9
v_xor_b32 v9, 32, v8
buffer_load_dwordx4 v206, s[24:27], s66 offen offset:2048  lds
v_add_u32 v113, v7, v9
v_xor_b32 v9, 64, v8
v_add_u32 v114, v7, v9
v_xor_b32 v9, 96, v8
v_add_u32 v115, v7, v9
v_mov_b32 v0, 0
v_mov_b32 v1, 0
v_mov_b32 v2, 0
v_mov_b32 v3, 0
v_mov_b32 v4, 0
v_mov_b32 v5, 0
v_mov_b32 v6, 0
v_mov_b32 v7, 0
buffer_load_dwordx4 v207, s[24:27], s66 offen offset:3072  lds
v_mov_b32 v8, 0
v_mov_b32 v9, 0
v_mov_b32 v10, 0
v_mov_b32 v11, 0
v_mov_b32 v12, 0
v_mov_b32 v13, 0
v_mov_b32 v14, 0
v_mov_b32 v15, 0
s_add_u32 s64, s67, 6
s_and_b32 s64, s64, 31
s_mul_i32 s66, s64, 36864
s_add_u32 m0, s51, 24576
s_nop 0
buffer_load_dwordx4 v204, s[24:27], s66 offen  lds
v_mov_b32 v16, 0
v_mov_b32 v17, 0
v_mov_b32 v18, 0
v_mov_b32 v19, 0
v_mov_b32 v20, 0
v_mov_b32 v21, 0
v_mov_b32 v22, 0
v_mov_b32 v23, 0
buffer_load_dwordx4 v205, s[24:27], s66 offen offset:1024  lds
v_mov_b32 v24, 0
v_mov_b32 v25, 0
v_mov_b32 v26, 0
v_mov_b32 v27, 0
v_mov_b32 v28, 0
v_mov_b32 v29, 0
v_mov_b32 v30, 0
v_mov_b32 v31, 0
buffer_load_dwordx4 v206, s[24:27], s66 offen offset:2048  lds
buffer_load_dwordx4 v207, s[24:27], s66 offen offset:3072  lds
s_add_u32 s64, s67, 7
s_and_b32 s64, s64, 31
s_mul_i32 s66, s64, 36864
s_add_u32 m0, s51, 28672
s_nop 0
buffer_load_dwordx4 v204, s[24:27], s66 offen  lds
buffer_load_dwordx4 v205, s[24:27], s66 offen offset:1024  lds
buffer_load_dwordx4 v206, s[24:27], s66 offen offset:2048  lds
buffer_load_dwordx4 v207, s[24:27], s66 offen offset:3072  lds
s_add_u32 s64, s67, 8
s_and_b32 s64, s64, 31
s_mul_i32 s66, s64, 36864
s_add_u32 m0, s51, 32768
s_nop 0
buffer_load_dwordx4 v204, s[24:27], s66 offen  lds
buffer_load_dwordx4 v205, s[24:27], s66 offen offset:1024  lds
buffer_load_dwordx4 v206, s[24:27], s66 offen offset:2048  lds
buffer_load_dwordx4 v207, s[24:27], s66 offen offset:3072  lds
s_add_u32 s64, s67, 9
s_and_b32 s64, s64, 31
s_mul_i32 s66, s64, 36864
s_add_u32 m0, s51, 36864
s_nop 0
buffer_load_dwordx4 v204, s[24:27], s66 offen  lds
buffer_load_dwordx4 v205, s[24:27], s66 offen offset:1024  lds
buffer_load_dwordx4 v206, s[24:27], s66 offen offset:2048  lds
buffer_load_dwordx4 v207, s[24:27], s66 offen offset:3072  lds
s_waitcnt vmcnt(40)
ds_read_b64_tr_b16 a[0:1], v112 offset:0
ds_read_b64_tr_b16 a[2:3], v112 offset:2048
ds_read_b64_tr_b16 a[4:5], v113 offset:0
ds_read_b64_tr_b16 a[6:7], v113 offset:2048
ds_read_b64_tr_b16 a[8:9], v114 offset:0
ds_read_b64_tr_b16 a[10:11], v114 offset:2048
ds_read_b64_tr_b16 a[12:13], v115 offset:0
ds_read_b64_tr_b16 a[14:15], v115 offset:2048
s_waitcnt lgkmcnt(0)
s_waitcnt vmcnt(35)
s_add_u32 s64, s67, 10
s_and_b32 s64, s64, 31
s_mul_i32 s66, s64, 36864
s_add_u32 m0, s51, 0
s_nop 0
buffer_load_dwordx4 v204, s[24:27], s66 offen  lds
ds_read_b64_tr_b16 a[16:17], v112 offset:4096
ds_read_b64_tr_b16 a[18:19], v112 offset:6144
buffer_load_dwordx4 v205, s[24:27], s66 offen offset:1024  lds
ds_read_b64_tr_b16 a[20:21], v113 offset:4096
ds_read_b64_tr_b16 a[22:23], v113 offset:6144
buffer_load_dwordx4 v206, s[24:27], s66 offen offset:2048  lds
ds_read_b64_tr_b16 a[24:25], v114 offset:4096
ds_read_b64_tr_b16 a[26:27], v114 offset:6144
buffer_load_dwordx4 v207, s[24:27], s66 offen offset:3072  lds
ds_read_b64_tr_b16 a[28:29], v115 offset:4096
ds_read_b64_tr_b16 a[30:31], v115 offset:6144
s_waitcnt lgkmcnt(0)
s_waitcnt vmcnt(34)
s_add_u32 s64, s67, 11
s_and_b32 s64, s64, 31
s_mul_i32 s66, s64, 36864
s_add_u32 m0, s51, 4096
s_nop 0
buffer_load_dwordx4 v204, s[24:27], s66 offen  lds
ds_read_b64_tr_b16 a[32:33], v112 offset:8192
ds_read_b64_tr_b16 a[34:35], v112 offset:10240
buffer_load_dwordx4 v205, s[24:27], s66 offen offset:1024  lds
ds_read_b64_tr_b16 a[36:37], v113 offset:8192
ds_read_b64_tr_b16 a[38:39], v113 offset:10240
buffer_load_dwordx4 v206, s[24:27], s66 offen offset:2048  lds
ds_read_b64_tr_b16 a[40:41], v114 offset:8192
ds_read_b64_tr_b16 a[42:43], v114 offset:10240
buffer_load_dwordx4 v207, s[24:27], s66 offen offset:3072  lds
ds_read_b64_tr_b16 a[44:45], v115 offset:8192
ds_read_b64_tr_b16 a[46:47], v115 offset:10240
s_waitcnt vmcnt(27)
s_barrier
s_cmp_eq_u32 s44, 0
s_cbranch_scc0 L_nosig
s_lshl_b32 s47, s45, 5
v_mov_b32 v210, s47
v_mov_b32 v211, 1
v_cmp_eq_u32 vcc, 0, v221
s_and_saveexec_b64 s[68:69], vcc
global_atomic_add v210, v211, s[16:17] sc1
s_mov_b64 exec, s[68:69]
L_nosig:
s_cmp_ge_u32 s70, 252
s_cbranch_scc1 L_attn_end
s_waitcnt lgkmcnt(0)
s_waitcnt vmcnt(34)
s_add_u32 s64, s67, 12
s_and_b32 s64, s64, 31
s_mul_i32 s66, s64, 36864
s_add_u32 m0, s51, 8192
s_nop 0
buffer_load_dwordx4 v204, s[24:27], s66 offen  lds
ds_read_b64_tr_b16 a[48:49], v112 offset:12288
ds_read_b64_tr_b16 a[50:51], v112 offset:14336
buffer_load_dwordx4 v205, s[24:27], s66 offen offset:1024  lds
ds_read_b64_tr_b16 a[52:53], v113 offset:12288
ds_read_b64_tr_b16 a[54:55], v113 offset:14336
buffer_load_dwordx4 v206, s[24:27], s66 offen offset:2048  lds
ds_read_b64_tr_b16 a[56:57], v114 offset:12288
ds_read_b64_tr_b16 a[58:59], v114 offset:14336
buffer_load_dwordx4 v207, s[24:27], s66 offen offset:3072  lds
ds_read_b64_tr_b16 a[60:61], v115 offset:12288
ds_read_b64_tr_b16 a[62:63], v115 offset:14336
s_waitcnt lgkmcnt(0)
s_waitcnt vmcnt(33)
s_add_u32 s64, s67, 13
s_and_b32 s64, s64, 31
s_mul_i32 s66, s64, 36864
s_add_u32 m0, s51, 12288
s_nop 0
buffer_load_dwordx4 v204, s[24:27], s66 offen  lds
ds_read_b64_tr_b16 a[64:65], v112 offset:16384
ds_read_b64_tr_b16 a[66:67], v112 offset:18432
buffer_load_dwordx4 v205, s[24:27], s66 offen offset:1024  lds
ds_read_b64_tr_b16 a[68:69], v113 offset:16384
ds_read_b64_tr_b16 a[70:71], v113 offset:18432
buffer_load_dwordx4 v206, s[24:27], s66 offen offset:2048  lds
ds_read_b64_tr_b16 a[72:73], v114 offset:16384
ds_read_b64_tr_b16 a[74:75], v114 offset:18432
buffer_load_dwordx4 v207, s[24:27], s66 offen offset:3072  lds
ds_read_b64_tr_b16 a[76:77], v115 offset:16384
ds_read_b64_tr_b16 a[78:79], v115 offset:18432
s_waitcnt lgkmcnt(0)
s_waitcnt vmcnt(32)
s_add_u32 s64, s67, 14
s_and_b32 s64, s64, 31
s_mul_i32 s66, s64, 36864
s_add_u32 m0, s51, 16384
s_nop 0
buffer_load_dwordx4 v204, s[24:27], s66 offen  lds
ds_read_b64_tr_b16 a[80:81], v112 offset:20480
ds_read_b64_tr_b16 a[82:83], v112 offset:22528
buffer_load_dwordx4 v205, s[24:27], s66 offen offset:1024  lds
ds_read_b64_tr_b16 a[84:85], v113 offset:20480
ds_read_b64_tr_b16 a[86:87], v113 offset:22528
buffer_load_dwordx4 v206, s[24:27], s66 offen offset:2048  lds
ds_read_b64_tr_b16 a[88:89], v114 offset:20480
ds_read_b64_tr_b16 a[90:91], v114 offset:22528
buffer_load_dwordx4 v207, s[24:27], s66 offen offset:3072  lds
ds_read_b64_tr_b16 a[92:93], v115 offset:20480
ds_read_b64_tr_b16 a[94:95], v115 offset:22528
s_waitcnt lgkmcnt(0)
s_waitcnt vmcnt(32)
s_add_u32 s64, s67, 15
s_and_b32 s64, s64, 31
s_mul_i32 s66, s64, 36864
s_add_u32 m0, s51, 20480
s_nop 0
buffer_load_dwordx4 v204, s[24:27], s66 offen  lds
ds_read_b64_tr_b16 a[96:97], v112 offset:24576
ds_read_b64_tr_b16 a[98:99], v112 offset:26624
buffer_load_dwordx4 v205, s[24:27], s66 offen offset:1024  lds
ds_read_b64_tr_b16 a[100:101], v113 offset:24576
ds_read_b64_tr_b16 a[102:103], v113 offset:26624
buffer_load_dwordx4 v206, s[24:27], s66 offen offset:2048  lds
ds_read_b64_tr_b16 a[104:105], v114 offset:24576
ds_read_b64_tr_b16 a[106:107], v114 offset:26624
buffer_load_dwordx4 v207, s[24:27], s66 offen offset:3072  lds
ds_read_b64_tr_b16 a[108:109], v115 offset:24576
ds_read_b64_tr_b16 a[110:111], v115 offset:26624
s_waitcnt lgkmcnt(0)
s_waitcnt vmcnt(32)
s_add_u32 s64, s67, 16
s_and_b32 s64, s64, 31
s_mul_i32 s66, s64, 36864
s_add_u32 m0, s51, 24576
s_nop 0
buffer_load_dwordx4 v204, s[24:27], s66 offen  lds
ds_read_b64_tr_b16 a[112:113], v112 offset:28672
ds_read_b64_tr_b16 a[114:115], v112 offset:30720
buffer_load_dwordx4 v205, s[24:27], s66 offen offset:1024  lds
ds_read_b64_tr_b16 a[116:117], v113 offset:28672
ds_read_b64_tr_b16 a[118:119], v113 offset:30720
buffer_load_dwordx4 v206, s[24:27], s66 offen offset:2048  lds
ds_read_b64_tr_b16 a[120:121], v114 offset:28672
ds_read_b64_tr_b16 a[122:123], v114 offset:30720
buffer_load_dwordx4 v207, s[24:27], s66 offen offset:3072  lds
ds_read_b64_tr_b16 a[124:125], v115 offset:28672
ds_read_b64_tr_b16 a[126:127], v115 offset:30720
s_waitcnt lgkmcnt(0)
s_waitcnt vmcnt(32)
s_add_u32 s64, s67, 17
s_and_b32 s64, s64, 31
s_mul_i32 s66, s64, 36864
s_add_u32 m0, s51, 28672
s_nop 0
buffer_load_dwordx4 v204, s[24:27], s66 offen  lds
ds_read_b64_tr_b16 a[128:129], v112 offset:32768
ds_read_b64_tr_b16 a[130:131], v112 offset:34816
buffer_load_dwordx4 v205, s[24:27], s66 offen offset:1024  lds
ds_read_b64_tr_b16 a[132:133], v113 offset:32768
ds_read_b64_tr_b16 a[134:135], v113 offset:34816
buffer_load_dwordx4 v206, s[24:27], s66 offen offset:2048  lds
ds_read_b64_tr_b16 a[136:137], v114 offset:32768
ds_read_b64_tr_b16 a[138:139], v114 offset:34816
buffer_load_dwordx4 v207, s[24:27], s66 offen offset:3072  lds
ds_read_b64_tr_b16 a[140:141], v115 offset:32768
ds_read_b64_tr_b16 a[142:143], v115 offset:34816
s_waitcnt lgkmcnt(0)
s_waitcnt vmcnt(32)
s_add_u32 s64, s67, 18
s_and_b32 s64, s64, 31
s_mul_i32 s66, s64, 36864
s_add_u32 m0, s51, 32768
s_nop 0
buffer_load_dwordx4 v204, s[24:27], s66 offen  lds
ds_read_b64_tr_b16 a[144:145], v112 offset:36864
ds_read_b64_tr_b16 a[146:147], v112 offset:38912
buffer_load_dwordx4 v205, s[24:27], s66 offen offset:1024  lds
ds_read_b64_tr_b16 a[148:149], v113 offset:36864
ds_read_b64_tr_b16 a[150:151], v113 offset:38912
buffer_load_dwordx4 v206, s[24:27], s66 offen offset:2048  lds
ds_read_b64_tr_b16 a[152:153], v114 offset:36864
ds_read_b64_tr_b16 a[154:155], v114 offset:38912
buffer_load_dwordx4 v207, s[24:27], s66 offen offset:3072  lds
ds_read_b64_tr_b16 a[156:157], v115 offset:36864
ds_read_b64_tr_b16 a[158:159], v115 offset:38912
s_waitcnt lgkmcnt(0)
s_waitcnt vmcnt(32)
s_add_u32 s64, s67, 19
s_and_b32 s64, s64, 31
s_mul_i32 s66, s64, 36864
s_add_u32 m0, s51, 36864
s_nop 0
buffer_load_dwordx4 v204, s[24:27], s66 offen  lds
ds_read_b64_tr_b16 a[160:161], v112 offset:0
ds_read_b64_tr_b16 a[162:163], v112 offset:2048
buffer_load_dwordx4 v205, s[24:27], s66 offen offset:1024  lds
ds_read_b64_tr_b16 a[164:165], v113 offset:0
ds_read_b64_tr_b16 a[166:167], v113 offset:2048
buffer_load_dwordx4 v206, s[24:27], s66 offen offset:2048  lds
ds_read_b64_tr_b16 a[168:169], v114 offset:0
ds_read_b64_tr_b16 a[170:171], v114 offset:2048
buffer_load_dwordx4 v207, s[24:27], s66 offen offset:3072  lds
ds_read_b64_tr_b16 a[172:173], v115 offset:0
ds_read_b64_tr_b16 a[174:175], v115 offset:2048
s_waitcnt lgkmcnt(0)
s_waitcnt vmcnt(32)
s_add_u32 s64, s67, 20
s_and_b32 s64, s64, 31
s_mul_i32 s66, s64, 36864
s_add_u32 m0, s51, 0
s_nop 0
buffer_load_dwordx4 v204, s[24:27], s66 offen  lds
ds_read_b64_tr_b16 a[176:177], v112 offset:4096
ds_read_b64_tr_b16 a[178:179], v112 offset:6144
buffer_load_dwordx4 v205, s[24:27], s66 offen offset:1024  lds
ds_read_b64_tr_b16 a[180:181], v113 offset:4096
ds_read_b64_tr_b16 a[182:183], v113 offset:6144
buffer_load_dwordx4 v206, s[24:27], s66 offen offset:2048  lds
ds_read_b64_tr_b16 a[184:185], v114 offset:4096
ds_read_b64_tr_b16 a[186:187], v114 offset:6144
buffer_load_dwordx4 v207, s[24:27], s66 offen offset:3072  lds
ds_read_b64_tr_b16 a[188:189], v115 offset:4096
ds_read_b64_tr_b16 a[190:191], v115 offset:6144
s_waitcnt lgkmcnt(0)
s_waitcnt vmcnt(32)
s_add_u32 s64, s67, 21
s_and_b32 s64, s64, 31
s_mul_i32 s66, s64, 36864
s_add_u32 m0, s51, 4096
s_nop 0
buffer_load_dwordx4 v204, s[24:27], s66 offen  lds
ds_read_b64_tr_b16 a[192:193], v112 offset:8192
ds_read_b64_tr_b16 a[194:195], v112 offset:10240
buffer_load_dwordx4 v205, s[24:27], s66 offen offset:1024  lds
ds_read_b64_tr_b16 a[196:197], v113 offset:8192
ds_read_b64_tr_b16 a[198:199], v113 offset:10240
buffer_load_dwordx4 v206, s[24:27], s66 offen offset:2048  lds
ds_read_b64_tr_b16 a[200:201], v114 offset:8192
ds_read_b64_tr_b16 a[202:203], v114 offset:10240
buffer_load_dwordx4 v207, s[24:27], s66 offen offset:3072  lds
ds_read_b64_tr_b16 a[204:205], v115 offset:8192
ds_read_b64_tr_b16 a[206:207], v115 offset:10240
s_waitcnt lgkmcnt(0)
s_waitcnt vmcnt(32)
s_add_u32 s64, s67, 22
s_and_b32 s64, s64, 31
s_mul_i32 s66, s64, 36864
s_add_u32 m0, s51, 8192
s_nop 0
buffer_load_dwordx4 v204, s[24:27], s66 offen  lds
ds_read_b64_tr_b16 a[208:209], v112 offset:12288
ds_read_b64_tr_b16 a[210:211], v112 offset:14336
buffer_load_dwordx4 v205, s[24:27], s66 offen offset:1024  lds
ds_read_b64_tr_b16 a[212:213], v113 offset:12288
ds_read_b64_tr_b16 a[214:215], v113 offset:14336
buffer_load_dwordx4 v206, s[24:27], s66 offen offset:2048  lds
ds_read_b64_tr_b16 a[216:217], v114 offset:12288
ds_read_b64_tr_b16 a[218:219], v114 offset:14336
buffer_load_dwordx4 v207, s[24:27], s66 offen offset:3072  lds
ds_read_b64_tr_b16 a[220:221], v115 offset:12288
ds_read_b64_tr_b16 a[222:223], v115 offset:14336
s_waitcnt lgkmcnt(0)
s_waitcnt vmcnt(32)
s_add_u32 s64, s67, 23
s_and_b32 s64, s64, 31
s_mul_i32 s66, s64, 36864
s_add_u32 m0, s51, 12288
s_nop 0
buffer_load_dwordx4 v204, s[24:27], s66 offen  lds
ds_read_b64_tr_b16 a[224:225], v112 offset:16384
ds_read_b64_tr_b16 a[226:227], v112 offset:18432
buffer_load_dwordx4 v205, s[24:27], s66 offen offset:1024  lds
ds_read_b64_tr_b16 a[228:229], v113 offset:16384
ds_read_b64_tr_b16 a[230:231], v113 offset:18432
buffer_load_dwordx4 v206, s[24:27], s66 offen offset:2048  lds
ds_read_b64_tr_b16 a[232:233], v114 offset:16384
ds_read_b64_tr_b16 a[234:235], v114 offset:18432
buffer_load_dwordx4 v207, s[24:27], s66 offen offset:3072  lds
ds_read_b64_tr_b16 a[236:237], v115 offset:16384
ds_read_b64_tr_b16 a[238:239], v115 offset:18432
s_waitcnt lgkmcnt(0)
s_waitcnt vmcnt(32)
s_add_u32 s64, s67, 24
s_and_b32 s64, s64, 31
s_mul_i32 s66, s64, 36864
s_add_u32 m0, s51, 16384
s_nop 0
buffer_load_dwordx4 v204, s[24:27], s66 offen  lds
ds_read_b64_tr_b16 a[240:241], v112 offset:20480
ds_read_b64_tr_b16 a[242:243], v112 offset:22528
buffer_load_dwordx4 v205, s[24:27], s66 offen offset:1024  lds
ds_read_b64_tr_b16 a[244:245], v113 offset:20480
ds_read_b64_tr_b16 a[246:247], v113 offset:22528
buffer_load_dwordx4 v206, s[24:27], s66 offen offset:2048  lds
ds_read_b64_tr_b16 a[248:249], v114 offset:20480
ds_read_b64_tr_b16 a[250:251], v114 offset:22528
buffer_load_dwordx4 v207, s[24:27], s66 offen offset:3072  lds
ds_read_b64_tr_b16 a[252:253], v115 offset:20480
ds_read_b64_tr_b16 a[254:255], v115 offset:22528
s_waitcnt lgkmcnt(0)
s_waitcnt vmcnt(32)
s_add_u32 s64, s67, 25
s_and_b32 s64, s64, 31
s_mul_i32 s66, s64, 36864
s_add_u32 m0, s51, 20480
s_nop 0
buffer_load_dwordx4 v204, s[24:27], s66 offen  lds
ds_read_b64_tr_b16 v[120:121], v112 offset:24576
ds_read_b64_tr_b16 v[122:123], v112 offset:26624
buffer_load_dwordx4 v205, s[24:27], s66 offen offset:1024  lds
ds_read_b64_tr_b16 v[124:125], v113 offset:24576
ds_read_b64_tr_b16 v[126:127], v113 offset:26624
buffer_load_dwordx4 v206, s[24:27], s66 offen offset:2048  lds
ds_read_b64_tr_b16 v[128:129], v114 offset:24576
ds_read_b64_tr_b16 v[130:131], v114 offset:26624
buffer_load_dwordx4 v207, s[24:27], s66 offen offset:3072  lds
ds_read_b64_tr_b16 v[132:133], v115 offset:24576
ds_read_b64_tr_b16 v[134:135], v115 offset:26624
s_waitcnt lgkmcnt(0)
s_waitcnt vmcnt(32)
s_add_u32 s64, s67, 26
s_and_b32 s64, s64, 31
s_mul_i32 s66, s64, 36864
s_add_u32 m0, s51, 24576
s_nop 0
buffer_load_dwordx4 v204, s[24:27], s66 offen  lds
ds_read_b64_tr_b16 v[136:137], v112 offset:28672
ds_read_b64_tr_b16 v[138:139], v112 offset:30720
buffer_load_dwordx4 v205, s[24:27], s66 offen offset:1024  lds
ds_read_b64_tr_b16 v[140:141], v113 offset:28672
ds_read_b64_tr_b16 v[142:143], v113 offset:30720
buffer_load_dwordx4 v206, s[24:27], s66 offen offset:2048  lds
ds_read_b64_tr_b16 v[144:145], v114 offset:28672
ds_read_b64_tr_b16 v[146:147], v114 offset:30720
buffer_load_dwordx4 v207, s[24:27], s66 offen offset:3072  lds
ds_read_b64_tr_b16 v[148:149], v115 offset:28672
ds_read_b64_tr_b16 v[150:151], v115 offset:30720
s_waitcnt lgkmcnt(0)
s_waitcnt vmcnt(32)
s_add_u32 s64, s67, 27
s_and_b32 s64, s64, 31
s_mul_i32 s66, s64, 36864
s_add_u32 m0, s51, 28672
s_nop 0
buffer_load_dwordx4 v204, s[24:27], s66 offen  lds
ds_read_b64_tr_b16 v[152:153], v112 offset:32768
ds_read_b64_tr_b16 v[154:155], v112 offset:34816
buffer_load_dwordx4 v205, s[24:27], s66 offen offset:1024  lds
ds_read_b64_tr_b16 v[156:157], v113 offset:32768
ds_read_b64_tr_b16 v[158:159], v113 offset:34816
buffer_load_dwordx4 v206, s[24:27], s66 offen offset:2048  lds
ds_read_b64_tr_b16 v[160:161], v114 offset:32768
ds_read_b64_tr_b16 v[162:163], v114 offset:34816
buffer_load_dwordx4 v207, s[24:27], s66 offen offset:3072  lds
ds_read_b64_tr_b16 v[164:165], v115 offset:32768
ds_read_b64_tr_b16 v[166:167], v115 offset:34816
s_waitcnt lgkmcnt(0)
s_waitcnt vmcnt(32)
s_add_u32 s64, s67, 28
s_and_b32 s64, s64, 31
s_mul_i32 s66, s64, 36864
s_add_u32 m0, s51, 32768
s_nop 0
buffer_load_dwordx4 v204, s[24:27], s66 offen  lds
ds_read_b64_tr_b16 v[168:169], v112 offset:36864
ds_read_b64_tr_b16 v[170:171], v112 offset:38912
buffer_load_dwordx4 v205, s[24:27], s66 offen offset:1024  lds
ds_read_b64_tr_b16 v[172:173], v113 offset:36864
ds_read_b64_tr_b16 v[174:175], v113 offset:38912
buffer_load_dwordx4 v206, s[24:27], s66 offen offset:2048  lds
ds_read_b64_tr_b16 v[176:177], v114 offset:36864
ds_read_b64_tr_b16 v[178:179], v114 offset:38912
buffer_load_dwordx4 v207, s[24:27], s66 offen offset:3072  lds
ds_read_b64_tr_b16 v[180:181], v115 offset:36864
ds_read_b64_tr_b16 v[182:183], v115 offset:38912
s_cmp_eq_u32 s44, 0
s_cbranch_scc0 L_noearly
s_lshl_b32 s47, s62, 1
s_mul_i32 s48, s47, 9363
s_lshr_b32 s48, s48, 16
s_add_u32 s47, s47, 1
s_mul_i32 s49, s47, 9363
s_lshr_b32 s49, s49, 16
v_and_b32 v210, 1, v221
v_mov_b32 v211, s48
v_mov_b32 v212, s49
v_cmp_eq_u32 vcc, 0, v210
s_nop 1
v_cndmask_b32 v211, v212, v211, vcc
v_lshlrev_b32 v211, 5, v211
global_load_dword v212, v211, s[16:17] sc1
L_noearly:
s_waitcnt lgkmcnt(0)
s_waitcnt vmcnt(32)
s_add_u32 s64, s67, 29
s_and_b32 s64, s64, 31
s_mul_i32 s66, s64, 36864
s_add_u32 m0, s51, 36864
s_nop 0
buffer_load_dwordx4 v204, s[24:27], s66 offen  lds
ds_read_b64_tr_b16 v[184:185], v112 offset:0
ds_read_b64_tr_b16 v[186:187], v112 offset:2048
buffer_load_dwordx4 v205, s[24:27], s66 offen offset:1024  lds
ds_read_b64_tr_b16 v[188:189], v113 offset:0
ds_read_b64_tr_b16 v[190:191], v113 offset:2048
buffer_load_dwordx4 v206, s[24:27], s66 offen offset:2048  lds
ds_read_b64_tr_b16 v[192:193], v114 offset:0
ds_read_b64_tr_b16 v[194:195], v114 offset:2048
buffer_load_dwordx4 v207, s[24:27], s66 offen offset:3072  lds
ds_read_b64_tr_b16 v[196:197], v115 offset:0
ds_read_b64_tr_b16 v[198:199], v115 offset:2048
s_waitcnt lgkmcnt(0)
s_waitcnt vmcnt(32)
s_add_u32 s64, s67, 30
s_and_b32 s64, s64, 31
s_mul_i32 s66, s64, 36864
s_add_u32 m0, s51, 0
s_nop 0
buffer_load_dwordx4 v204, s[24:27], s66 offen  lds
ds_read_b64_tr_b16 v[224:225], v112 offset:4096
ds_read_b64_tr_b16 v[226:227], v112 offset:6144
buffer_load_dwordx4 v205, s[24:27], s66 offen offset:1024  lds
ds_read_b64_tr_b16 v[228:229], v113 offset:4096
ds_read_b64_tr_b16 v[230:231], v113 offset:6144
buffer_load_dwordx4 v206, s[24:27], s66 offen offset:2048  lds
ds_read_b64_tr_b16 v[232:233], v114 offset:4096
ds_read_b64_tr_b16 v[234:235], v114 offset:6144
buffer_load_dwordx4 v207, s[24:27], s66 offen offset:3072  lds
ds_read_b64_tr_b16 v[236:237], v115 offset:4096
ds_read_b64_tr_b16 v[238:239], v115 offset:6144
s_waitcnt lgkmcnt(0)
s_add_u32 s64, s67, 31
s_and_b32 s64, s64, 31
s_mul_i32 s66, s64, 36864
s_add_u32 m0, s51, 4096
s_nop 0
buffer_load_dwordx4 v204, s[24:27], s66 offen  lds
buffer_load_dwordx4 v205, s[24:27], s66 offen offset:1024  lds
buffer_load_dwordx4 v206, s[24:27], s66 offen offset:2048  lds
buffer_load_dwordx4 v207, s[24:27], s66 offen offset:3072  lds
s_cmp_eq_u32 s44, 0
s_cbranch_scc0 L_polled
s_waitcnt vmcnt(12)
v_cmp_gt_u32 vcc, 32, v212
s_cbranch_vccz L_polled
s_mov_b32 s50, 0x8000
L_poll:
global_load_dword v212, v211, s[16:17] sc1
s_waitcnt vmcnt(0)
v_cmp_gt_u32 vcc, 32, v212
s_cbranch_vccz L_polled
s_sleep 16
s_sub_u32 s50, s50, 1
s_cmp_lg_u32 s50, 0
s_cbranch_scc1 L_poll
L_polled:
s_barrier
s_add_u32 s64, s67, 0
s_and_b32 s64, s64, 31
s_lshl_b32 s65, s64, 10
buffer_load_dwordx4 v[32:35], v116, s[20:23], s65 offen sc1
s_add_u32 s65, s65, 131072
buffer_load_dwordx4 v[36:39], v116, s[20:23], s65 offen sc1
s_add_u32 s64, s67, 1
s_and_b32 s64, s64, 31
s_lshl_b32 s65, s64, 10
buffer_load_dwordx4 v[40:43], v116, s[20:23], s65 offen sc1
s_add_u32 s65, s65, 131072
buffer_load_dwordx4 v[44:47], v116, s[20:23], s65 offen sc1
s_add_u32 s64, s67, 2
s_and_b32 s64, s64, 31
s_lshl_b32 s65, s64, 10
buffer_load_dwordx4 v[48:51], v116, s[20:23], s65 offen sc1
s_add_u32 s65, s65, 131072
buffer_load_dwordx4 v[52:55], v116, s[20:23], s65 offen sc1
s_add_u32 s64, s67, 3
s_and_b32 s64, s64, 31
s_lshl_b32 s65, s64, 10
buffer_load_dwordx4 v[56:59], v116, s[20:23], s65 offen sc1
s_add_u32 s65, s65, 131072
buffer_load_dwordx4 v[60:63], v116, s[20:23], s65 offen sc1
s_add_u32 s64, s67, 4
s_and_b32 s64, s64, 31
s_lshl_b32 s65, s64, 10
buffer_load_dwordx4 v[64:67], v116, s[20:23], s65 offen sc1
s_add_u32 s65, s65, 131072
buffer_load_dwordx4 v[68:71], v116, s[20:23], s65 offen sc1
s_waitcnt vmcnt(8)
v_mfma_f32_16x16x32_bf16 v[0:3], a[0:3], v[32:35], v[0:3]
v_mfma_f32_16x16x32_bf16 v[4:7], a[4:7], v[32:35], v[4:7]
s_add_u32 s64, s67, 5
s_and_b32 s64, s64, 31
s_lshl_b32 s65, s64, 10
buffer_load_dwordx4 v[72:75], v116, s[20:23], s65 offen sc1
v_mfma_f32_16x16x32_bf16 v[8:11], a[8:11], v[32:35], v[8:11]
s_add_u32 s65, s65, 131072
buffer_load_dwordx4 v[76:79], v116, s[20:23], s65 offen sc1
v_mfma_f32_16x16x32_bf16 v[12:15], a[12:15], v[32:35], v[12:15]
v_mfma_f32_16x16x32_bf16 v[16:19], a[0:3], v[36:39], v[16:19]
v_mfma_f32_16x16x32_bf16 v[20:23], a[4:7], v[36:39], v[20:23]
v_mfma_f32_16x16x32_bf16 v[24:27], a[8:11], v[36:39], v[24:27]
v_mfma_f32_16x16x32_bf16 v[28:31], a[12:15], v[36:39], v[28:31]
s_waitcnt vmcnt(8)
v_mfma_f32_16x16x32_bf16 v[0:3], a[16:19], v[40:43], v[0:3]
v_mfma_f32_16x16x32_bf16 v[4:7], a[20:23], v[40:43], v[4:7]
s_add_u32 s64, s67, 6
s_and_b32 s64, s64, 31
s_lshl_b32 s65, s64, 10
buffer_load_dwordx4 v[32:35], v116, s[20:23], s65 offen sc1
v_mfma_f32_16x16x32_bf16 v[8:11], a[24:27], v[40:43], v[8:11]
s_add_u32 s65, s65, 131072
buffer_load_dwordx4 v[36:39], v116, s[20:23], s65 offen sc1
v_mfma_f32_16x16x32_bf16 v[12:15], a[28:31], v[40:43], v[12:15]
v_mfma_f32_16x16x32_bf16 v[16:19], a[16:19], v[44:47], v[16:19]
v_mfma_f32_16x16x32_bf16 v[20:23], a[20:23], v[44:47], v[20:23]
v_mfma_f32_16x16x32_bf16 v[24:27], a[24:27], v[44:47], v[24:27]
v_mfma_f32_16x16x32_bf16 v[28:31], a[28:31], v[44:47], v[28:31]
s_waitcnt vmcnt(8)
v_mfma_f32_16x16x32_bf16 v[0:3], a[32:35], v[48:51], v[0:3]
v_mfma_f32_16x16x32_bf16 v[4:7], a[36:39], v[48:51], v[4:7]
s_add_u32 s64, s67, 7
s_and_b32 s64, s64, 31
s_lshl_b32 s65, s64, 10
buffer_load_dwordx4 v[40:43], v116, s[20:23], s65 offen sc1
v_mfma_f32_16x16x32_bf16 v[8:11], a[40:43], v[48:51], v[8:11]
s_add_u32 s65, s65, 131072
buffer_load_dwordx4 v[44:47], v116, s[20:23], s65 offen sc1
v_mfma_f32_16x16x32_bf16 v[12:15], a[44:47], v[48:51], v[12:15]
v_mfma_f32_16x16x32_bf16 v[16:19], a[32:35], v[52:55], v[16:19]
v_mfma_f32_16x16x32_bf16 v[20:23], a[36:39], v[52:55], v[20:23]
v_mfma_f32_16x16x32_bf16 v[24:27], a[40:43], v[52:55], v[24:27]
v_mfma_f32_16x16x32_bf16 v[28:31], a[44:47], v[52:55], v[28:31]
s_waitcnt vmcnt(8)
v_mfma_f32_16x16x32_bf16 v[0:3], a[48:51], v[56:59], v[0:3]
v_mfma_f32_16x16x32_bf16 v[4:7], a[52:55], v[56:59], v[4:7]
s_add_u32 s64, s67, 8
s_and_b32 s64, s64, 31
s_lshl_b32 s65, s64, 10
buffer_load_dwordx4 v[48:51], v116, s[20:23], s65 offen sc1
v_mfma_f32_16x16x32_bf16 v[8:11], a[56:59], v[56:59], v[8:11]
s_add_u32 s65, s65, 131072
buffer_load_dwordx4 v[52:55], v116, s[20:23], s65 offen sc1
v_mfma_f32_16x16x32_bf16 v[12:15], a[60:63], v[56:59], v[12:15]
v_mfma_f32_16x16x32_bf16 v[16:19], a[48:51], v[60:63], v[16:19]
v_mfma_f32_16x16x32_bf16 v[20:23], a[52:55], v[60:63], v[20:23]
v_mfma_f32_16x16x32_bf16 v[24:27], a[56:59], v[60:63], v[24:27]
v_mfma_f32_16x16x32_bf16 v[28:31], a[60:63], v[60:63], v[28:31]
s_waitcnt vmcnt(8)
v_mfma_f32_16x16x32_bf16 v[0:3], a[64:67], v[64:67], v[0:3]
v_mfma_f32_16x16x32_bf16 v[4:7], a[68:71], v[64:67], v[4:7]
s_add_u32 s64, s67, 9
s_and_b32 s64, s64, 31
s_lshl_b32 s65, s64, 10
buffer_load_dwordx4 v[56:59], v116, s[20:23], s65 offen sc1
v_mfma_f32_16x16x32_bf16 v[8:11], a[72:75], v[64:67], v[8:11]
s_add_u32 s65, s65, 131072
buffer_load_dwordx4 v[60:63], v116, s[20:23], s65 offen sc1
v_mfma_f32_16x16x32_bf16 v[12:15], a[76:79], v[64:67], v[12:15]
v_mfma_f32_16x16x32_bf16 v[16:19], a[64:67], v[68:71], v[16:19]
v_mfma_f32_16x16x32_bf16 v[20:23], a[68:71], v[68:71], v[20:23]
v_mfma_f32_16x16x32_bf16 v[24:27], a[72:75], v[68:71], v[24:27]
v_mfma_f32_16x16x32_bf16 v[28:31], a[76:79], v[68:71], v[28:31]
s_waitcnt vmcnt(8)
v_mfma_f32_16x16x32_bf16 v[0:3], a[80:83], v[72:75], v[0:3]
v_mfma_f32_16x16x32_bf16 v[4:7], a[84:87], v[72:75], v[4:7]
s_add_u32 s64, s67, 10
s_and_b32 s64, s64, 31
s_lshl_b32 s65, s64, 10
buffer_load_dwordx4 v[64:67], v116, s[20:23], s65 offen sc1
v_mfma_f32_16x16x32_bf16 v[8:11], a[88:91], v[72:75], v[8:11]
s_add_u32 s65, s65, 131072
buffer_load_dwordx4 v[68:71], v116, s[20:23], s65 offen sc1
v_mfma_f32_16x16x32_bf16 v[12:15], a[92:95], v[72:75], v[12:15]
v_mfma_f32_16x16x32_bf16 v[16:19], a[80:83], v[76:79], v[16:19]
v_mfma_f32_16x16x32_bf16 v[20:23], a[84:87], v[76:79], v[20:23]
v_mfma_f32_16x16x32_bf16 v[24:27], a[88:91], v[76:79], v[24:27]
v_mfma_f32_16x16x32_bf16 v[28:31], a[92:95], v[76:79], v[28:31]
s_waitcnt vmcnt(8)
v_mfma_f32_16x16x32_bf16 v[0:3], a[96:99], v[32:35], v[0:3]
v_mfma_f32_16x16x32_bf16 v[4:7], a[100:103], v[32:35], v[4:7]
s_add_u32 s64, s67, 11
s_and_b32 s64, s64, 31
s_lshl_b32 s65, s64, 10
buffer_load_dwordx4 v[72:75], v116, s[20:23], s65 offen sc1
v_mfma_f32_16x16x32_bf16 v[8:11], a[104:107], v[32:35], v[8:11]
s_add_u32 s65, s65, 131072
buffer_load_dwordx4 v[76:79], v116, s[20:23], s65 offen sc1
v_mfma_f32_16x16x32_bf16 v[12:15], a[108:111], v[32:35], v[12:15]
v_mfma_f32_16x16x32_bf16 v[16:19], a[96:99], v[36:39], v[16:19]
v_mfma_f32_16x16x32_bf16 v[20:23], a[100:103], v[36:39], v[20:23]
v_mfma_f32_16x16x32_bf16 v[24:27], a[104:107], v[36:39], v[24:27]
v_mfma_f32_16x16x32_bf16 v[28:31], a[108:111], v[36:39], v[28:31]
s_waitcnt vmcnt(8)
v_mfma_f32_16x16x32_bf16 v[0:3], a[112:115], v[40:43], v[0:3]
v_mfma_f32_16x16x32_bf16 v[4:7], a[116:119], v[40:43], v[4:7]
s_add_u32 s64, s67, 12
s_and_b32 s64, s64, 31
s_lshl_b32 s65, s64, 10
buffer_load_dwordx4 v[32:35], v116, s[20:23], s65 offen sc1
v_mfma_f32_16x16x32_bf16 v[8:11], a[120:123], v[40:43], v[8:11]
s_add_u32 s65, s65, 131072
buffer_load_dwordx4 v[36:39], v116, s[20:23], s65 offen sc1
v_mfma_f32_16x16x32_bf16 v[12:15], a[124:127], v[40:43], v[12:15]
v_mfma_f32_16x16x32_bf16 v[16:19], a[112:115], v[44:47], v[16:19]
v_mfma_f32_16x16x32_bf16 v[20:23], a[116:119], v[44:47], v[20:23]
v_mfma_f32_16x16x32_bf16 v[24:27], a[120:123], v[44:47], v[24:27]
v_mfma_f32_16x16x32_bf16 v[28:31], a[124:127], v[44:47], v[28:31]
s_waitcnt vmcnt(8)
v_mfma_f32_16x16x32_bf16 v[0:3], a[128:131], v[48:51], v[0:3]
v_mfma_f32_16x16x32_bf16 v[4:7], a[132:135], v[48:51], v[4:7]
s_add_u32 s64, s67, 13
s_and_b32 s64, s64, 31
s_lshl_b32 s65, s64, 10
buffer_load_dwordx4 v[40:43], v116, s[20:23], s65 offen sc1
v_mfma_f32_16x16x32_bf16 v[8:11], a[136:139], v[48:51], v[8:11]
s_add_u32 s65, s65, 131072
buffer_load_dwordx4 v[44:47], v116, s[20:23], s65 offen sc1
v_mfma_f32_16x16x32_bf16 v[12:15], a[140:143], v[48:51], v[12:15]
v_mfma_f32_16x16x32_bf16 v[16:19], a[128:131], v[52:55], v[16:19]
v_mfma_f32_16x16x32_bf16 v[20:23], a[132:135], v[52:55], v[20:23]
v_mfma_f32_16x16x32_bf16 v[24:27], a[136:139], v[52:55], v[24:27]
v_mfma_f32_16x16x32_bf16 v[28:31], a[140:143], v[52:55], v[28:31]
s_waitcnt vmcnt(8)
v_mfma_f32_16x16x32_bf16 v[0:3], a[144:147], v[56:59], v[0:3]
v_mfma_f32_16x16x32_bf16 v[4:7], a[148:151], v[56:59], v[4:7]
s_add_u32 s64, s67, 14
s_and_b32 s64, s64, 31
s_lshl_b32 s65, s64, 10
buffer_load_dwordx4 v[48:51], v116, s[20:23], s65 offen sc1
v_mfma_f32_16x16x32_bf16 v[8:11], a[152:155], v[56:59], v[8:11]
s_add_u32 s65, s65, 131072
buffer_load_dwordx4 v[52:55], v116, s[20:23], s65 offen sc1
v_mfma_f32_16x16x32_bf16 v[12:15], a[156:159], v[56:59], v[12:15]
v_mfma_f32_16x16x32_bf16 v[16:19], a[144:147], v[60:63], v[16:19]
v_mfma_f32_16x16x32_bf16 v[20:23], a[148:151], v[60:63], v[20:23]
v_mfma_f32_16x16x32_bf16 v[24:27], a[152:155], v[60:63], v[24:27]
v_mfma_f32_16x16x32_bf16 v[28:31], a[156:159], v[60:63], v[28:31]
s_waitcnt vmcnt(8)
v_mfma_f32_16x16x32_bf16 v[0:3], a[160:163], v[64:67], v[0:3]
v_mfma_f32_16x16x32_bf16 v[4:7], a[164:167], v[64:67], v[4:7]
s_add_u32 s64, s67, 15
s_and_b32 s64, s64, 31
s_lshl_b32 s65, s64, 10
buffer_load_dwordx4 v[56:59], v116, s[20:23], s65 offen sc1
v_mfma_f32_16x16x32_bf16 v[8:11], a[168:171], v[64:67], v[8:11]
s_add_u32 s65, s65, 131072
buffer_load_dwordx4 v[60:63], v116, s[20:23], s65 offen sc1
v_mfma_f32_16x16x32_bf16 v[12:15], a[172:175], v[64:67], v[12:15]
v_mfma_f32_16x16x32_bf16 v[16:19], a[160:163], v[68:71], v[16:19]
v_mfma_f32_16x16x32_bf16 v[20:23], a[164:167], v[68:71], v[20:23]
v_mfma_f32_16x16x32_bf16 v[24:27], a[168:171], v[68:71], v[24:27]
v_mfma_f32_16x16x32_bf16 v[28:31], a[172:175], v[68:71], v[28:31]
s_waitcnt vmcnt(8)
v_mfma_f32_16x16x32_bf16 v[0:3], a[176:179], v[72:75], v[0:3]
v_mfma_f32_16x16x32_bf16 v[4:7], a[180:183], v[72:75], v[4:7]
s_add_u32 s64, s67, 16
s_and_b32 s64, s64, 31
s_lshl_b32 s65, s64, 10
buffer_load_dwordx4 v[64:67], v116, s[20:23], s65 offen sc1
v_mfma_f32_16x16x32_bf16 v[8:11], a[184:187], v[72:75], v[8:11]
s_add_u32 s65, s65, 131072
buffer_load_dwordx4 v[68:71], v116, s[20:23], s65 offen sc1
v_mfma_f32_16x16x32_bf16 v[12:15], a[188:191], v[72:75], v[12:15]
v_mfma_f32_16x16x32_bf16 v[16:19], a[176:179], v[76:79], v[16:19]
v_mfma_f32_16x16x32_bf16 v[20:23], a[180:183], v[76:79], v[20:23]
v_mfma_f32_16x16x32_bf16 v[24:27], a[184:187], v[76:79], v[24:27]
v_mfma_f32_16x16x32_bf16 v[28:31], a[188:191], v[76:79], v[28:31]
s_waitcnt vmcnt(8)
v_mfma_f32_16x16x32_bf16 v[0:3], a[192:195], v[32:35], v[0:3]
v_mfma_f32_16x16x32_bf16 v[4:7], a[196:199], v[32:35], v[4:7]
s_add_u32 s64, s67, 17
s_and_b32 s64, s64, 31
s_lshl_b32 s65, s64, 10
buffer_load_dwordx4 v[72:75], v116, s[20:23], s65 offen sc1
v_mfma_f32_16x16x32_bf16 v[8:11], a[200:203], v[32:35], v[8:11]
s_add_u32 s65, s65, 131072
buffer_load_dwordx4 v[76:79], v116, s[20:23], s65 offen sc1
v_mfma_f32_16x16x32_bf16 v[12:15], a[204:207], v[32:35], v[12:15]
v_mfma_f32_16x16x32_bf16 v[16:19], a[192:195], v[36:39], v[16:19]
v_mfma_f32_16x16x32_bf16 v[20:23], a[196:199], v[36:39], v[20:23]
v_mfma_f32_16x16x32_bf16 v[24:27], a[200:203], v[36:39], v[24:27]
v_mfma_f32_16x16x32_bf16 v[28:31], a[204:207], v[36:39], v[28:31]
s_waitcnt vmcnt(8)
v_mfma_f32_16x16x32_bf16 v[0:3], a[208:211], v[40:43], v[0:3]
v_mfma_f32_16x16x32_bf16 v[4:7], a[212:215], v[40:43], v[4:7]
s_add_u32 s64, s67, 18
s_and_b32 s64, s64, 31
s_lshl_b32 s65, s64, 10
buffer_load_dwordx4 v[32:35], v116, s[20:23], s65 offen sc1
v_mfma_f32_16x16x32_bf16 v[8:11], a[216:219], v[40:43], v[8:11]
s_add_u32 s65, s65, 131072
buffer_load_dwordx4 v[36:39], v116, s[20:23], s65 offen sc1
v_mfma_f32_16x16x32_bf16 v[12:15], a[220:223], v[40:43], v[12:15]
v_mfma_f32_16x16x32_bf16 v[16:19], a[208:211], v[44:47], v[16:19]
v_mfma_f32_16x16x32_bf16 v[20:23], a[212:215], v[44:47], v[20:23]
v_mfma_f32_16x16x32_bf16 v[24:27], a[216:219], v[44:47], v[24:27]
v_mfma_f32_16x16x32_bf16 v[28:31], a[220:223], v[44:47], v[28:31]
s_waitcnt vmcnt(8)
v_mfma_f32_16x16x32_bf16 v[0:3], a[224:227], v[48:51], v[0:3]
v_mfma_f32_16x16x32_bf16 v[4:7], a[228:231], v[48:51], v[4:7]
s_add_u32 s64, s67, 19
s_and_b32 s64, s64, 31
s_lshl_b32 s65, s64, 10
buffer_load_dwordx4 v[40:43], v116, s[20:23], s65 offen sc1
v_mfma_f32_16x16x32_bf16 v[8:11], a[232:235], v[48:51], v[8:11]
s_add_u32 s65, s65, 131072
buffer_load_dwordx4 v[44:47], v116, s[20:23], s65 offen sc1
v_mfma_f32_16x16x32_bf16 v[12:15], a[236:239], v[48:51], v[12:15]
v_mfma_f32_16x16x32_bf16 v[16:19], a[224:227], v[52:55], v[16:19]
v_mfma_f32_16x16x32_bf16 v[20:23], a[228:231], v[52:55], v[20:23]
v_mfma_f32_16x16x32_bf16 v[24:27], a[232:235], v[52:55], v[24:27]
v_mfma_f32_16x16x32_bf16 v[28:31], a[236:239], v[52:55], v[28:31]
s_waitcnt vmcnt(8)
v_mfma_f32_16x16x32_bf16 v[0:3], a[240:243], v[56:59], v[0:3]
v_mfma_f32_16x16x32_bf16 v[4:7], a[244:247], v[56:59], v[4:7]
s_add_u32 s64, s67, 20
s_and_b32 s64, s64, 31
s_lshl_b32 s65, s64, 10
buffer_load_dwordx4 v[48:51], v116, s[20:23], s65 offen sc1
v_mfma_f32_16x16x32_bf16 v[8:11], a[248:251], v[56:59], v[8:11]
s_add_u32 s65, s65, 131072
buffer_load_dwordx4 v[52:55], v116, s[20:23], s65 offen sc1
v_mfma_f32_16x16x32_bf16 v[12:15], a[252:255], v[56:59], v[12:15]
v_mfma_f32_16x16x32_bf16 v[16:19], a[240:243], v[60:63], v[16:19]
v_mfma_f32_16x16x32_bf16 v[20:23], a[244:247], v[60:63], v[20:23]
v_mfma_f32_16x16x32_bf16 v[24:27], a[248:251], v[60:63], v[24:27]
v_mfma_f32_16x16x32_bf16 v[28:31], a[252:255], v[60:63], v[28:31]
s_waitcnt vmcnt(8)
v_mfma_f32_16x16x32_bf16 v[0:3], v[120:123], v[64:67], v[0:3]
v_mfma_f32_16x16x32_bf16 v[4:7], v[124:127], v[64:67], v[4:7]
s_add_u32 s64, s67, 21
s_and_b32 s64, s64, 31
s_lshl_b32 s65, s64, 10
buffer_load_dwordx4 v[56:59], v116, s[20:23], s65 offen sc1
v_mfma_f32_16x16x32_bf16 v[8:11], v[128:131], v[64:67], v[8:11]
s_add_u32 s65, s65, 131072
buffer_load_dwordx4 v[60:63], v116, s[20:23], s65 offen sc1
v_mfma_f32_16x16x32_bf16 v[12:15], v[132:135], v[64:67], v[12:15]
v_mfma_f32_16x16x32_bf16 v[16:19], v[120:123], v[68:71], v[16:19]
v_mfma_f32_16x16x32_bf16 v[20:23], v[124:127], v[68:71], v[20:23]
v_mfma_f32_16x16x32_bf16 v[24:27], v[128:131], v[68:71], v[24:27]
v_mfma_f32_16x16x32_bf16 v[28:31], v[132:135], v[68:71], v[28:31]
s_waitcnt vmcnt(8)
v_mfma_f32_16x16x32_bf16 v[0:3], v[136:139], v[72:75], v[0:3]
v_mfma_f32_16x16x32_bf16 v[4:7], v[140:143], v[72:75], v[4:7]
s_add_u32 s64, s67, 22
s_and_b32 s64, s64, 31
s_lshl_b32 s65, s64, 10
buffer_load_dwordx4 v[64:67], v116, s[20:23], s65 offen sc1
v_mfma_f32_16x16x32_bf16 v[8:11], v[144:147], v[72:75], v[8:11]
s_add_u32 s65, s65, 131072
buffer_load_dwordx4 v[68:71], v116, s[20:23], s65 offen sc1
v_mfma_f32_16x16x32_bf16 v[12:15], v[148:151], v[72:75], v[12:15]
v_mfma_f32_16x16x32_bf16 v[16:19], v[136:139], v[76:79], v[16:19]
v_mfma_f32_16x16x32_bf16 v[20:23], v[140:143], v[76:79], v[20:23]
v_mfma_f32_16x16x32_bf16 v[24:27], v[144:147], v[76:79], v[24:27]
v_mfma_f32_16x16x32_bf16 v[28:31], v[148:151], v[76:79], v[28:31]
s_waitcnt vmcnt(8)
v_mfma_f32_16x16x32_bf16 v[0:3], v[152:155], v[32:35], v[0:3]
v_mfma_f32_16x16x32_bf16 v[4:7], v[156:159], v[32:35], v[4:7]
s_add_u32 s64, s67, 23
s_and_b32 s64, s64, 31
s_lshl_b32 s65, s64, 10
buffer_load_dwordx4 v[72:75], v116, s[20:23], s65 offen sc1
v_mfma_f32_16x16x32_bf16 v[8:11], v[160:163], v[32:35], v[8:11]
s_add_u32 s65, s65, 131072
buffer_load_dwordx4 v[76:79], v116, s[20:23], s65 offen sc1
v_mfma_f32_16x16x32_bf16 v[12:15], v[164:167], v[32:35], v[12:15]
v_mfma_f32_16x16x32_bf16 v[16:19], v[152:155], v[36:39], v[16:19]
v_mfma_f32_16x16x32_bf16 v[20:23], v[156:159], v[36:39], v[20:23]
v_mfma_f32_16x16x32_bf16 v[24:27], v[160:163], v[36:39], v[24:27]
v_mfma_f32_16x16x32_bf16 v[28:31], v[164:167], v[36:39], v[28:31]
s_waitcnt vmcnt(8)
v_mfma_f32_16x16x32_bf16 v[0:3], v[168:171], v[40:43], v[0:3]
v_mfma_f32_16x16x32_bf16 v[4:7], v[172:175], v[40:43], v[4:7]
s_add_u32 s64, s67, 24
s_and_b32 s64, s64, 31
s_lshl_b32 s65, s64, 10
buffer_load_dwordx4 v[32:35], v116, s[20:23], s65 offen sc1
v_mfma_f32_16x16x32_bf16 v[8:11], v[176:179], v[40:43], v[8:11]
s_add_u32 s65, s65, 131072
buffer_load_dwordx4 v[36:39], v116, s[20:23], s65 offen sc1
v_mfma_f32_16x16x32_bf16 v[12:15], v[180:183], v[40:43], v[12:15]
v_mfma_f32_16x16x32_bf16 v[16:19], v[168:171], v[44:47], v[16:19]
v_mfma_f32_16x16x32_bf16 v[20:23], v[172:175], v[44:47], v[20:23]
v_mfma_f32_16x16x32_bf16 v[24:27], v[176:179], v[44:47], v[24:27]
v_mfma_f32_16x16x32_bf16 v[28:31], v[180:183], v[44:47], v[28:31]
s_waitcnt vmcnt(8)
v_mfma_f32_16x16x32_bf16 v[0:3], v[184:187], v[48:51], v[0:3]
v_mfma_f32_16x16x32_bf16 v[4:7], v[188:191], v[48:51], v[4:7]
s_add_u32 s64, s67, 25
s_and_b32 s64, s64, 31
s_lshl_b32 s65, s64, 10
buffer_load_dwordx4 v[40:43], v116, s[20:23], s65 offen sc1
v_mfma_f32_16x16x32_bf16 v[8:11], v[192:195], v[48:51], v[8:11]
s_add_u32 s65, s65, 131072
buffer_load_dwordx4 v[44:47], v116, s[20:23], s65 offen sc1
v_mfma_f32_16x16x32_bf16 v[12:15], v[196:199], v[48:51], v[12:15]
v_mfma_f32_16x16x32_bf16 v[16:19], v[184:187], v[52:55], v[16:19]
v_mfma_f32_16x16x32_bf16 v[20:23], v[188:191], v[52:55], v[20:23]
v_mfma_f32_16x16x32_bf16 v[24:27], v[192:195], v[52:55], v[24:27]
v_mfma_f32_16x16x32_bf16 v[28:31], v[196:199], v[52:55], v[28:31]
s_waitcnt vmcnt(8)
v_mfma_f32_16x16x32_bf16 v[0:3], v[224:227], v[56:59], v[0:3]
ds_read_b64_tr_b16 v[80:81], v112 offset:8192
v_mfma_f32_16x16x32_bf16 v[4:7], v[228:231], v[56:59], v[4:7]
ds_read_b64_tr_b16 v[82:83], v112 offset:10240
s_add_u32 s64, s67, 26
s_and_b32 s64, s64, 31
s_lshl_b32 s65, s64, 10
buffer_load_dwordx4 v[48:51], v116, s[20:23], s65 offen sc1
v_mfma_f32_16x16x32_bf16 v[8:11], v[232:235], v[56:59], v[8:11]
ds_read_b64_tr_b16 v[84:85], v113 offset:8192
s_add_u32 s65, s65, 131072
buffer_load_dwordx4 v[52:55], v116, s[20:23], s65 offen sc1
v_mfma_f32_16x16x32_bf16 v[12:15], v[236:239], v[56:59], v[12:15]
ds_read_b64_tr_b16 v[86:87], v113 offset:10240
v_mfma_f32_16x16x32_bf16 v[16:19], v[224:227], v[60:63], v[16:19]
ds_read_b64_tr_b16 v[88:89], v114 offset:8192
v_mfma_f32_16x16x32_bf16 v[20:23], v[228:231], v[60:63], v[20:23]
ds_read_b64_tr_b16 v[90:91], v114 offset:10240
v_mfma_f32_16x16x32_bf16 v[24:27], v[232:235], v[60:63], v[24:27]
ds_read_b64_tr_b16 v[92:93], v115 offset:8192
v_mfma_f32_16x16x32_bf16 v[28:31], v[236:239], v[60:63], v[28:31]
ds_read_b64_tr_b16 v[94:95], v115 offset:10240
s_waitcnt vmcnt(8)
s_waitcnt lgkmcnt(0)
v_mfma_f32_16x16x32_bf16 v[0:3], v[80:83], v[64:67], v[0:3]
ds_read_b64_tr_b16 v[96:97], v112 offset:12288
v_mfma_f32_16x16x32_bf16 v[4:7], v[84:87], v[64:67], v[4:7]
ds_read_b64_tr_b16 v[98:99], v112 offset:14336
s_add_u32 s64, s67, 27
s_and_b32 s64, s64, 31
s_lshl_b32 s65, s64, 10
buffer_load_dwordx4 v[56:59], v116, s[20:23], s65 offen sc1
v_mfma_f32_16x16x32_bf16 v[8:11], v[88:91], v[64:67], v[8:11]
ds_read_b64_tr_b16 v[100:101], v113 offset:12288
s_add_u32 s65, s65, 131072
buffer_load_dwordx4 v[60:63], v116, s[20:23], s65 offen sc1
v_mfma_f32_16x16x32_bf16 v[12:15], v[92:95], v[64:67], v[12:15]
ds_read_b64_tr_b16 v[102:103], v113 offset:14336
v_mfma_f32_16x16x32_bf16 v[16:19], v[80:83], v[68:71], v[16:19]
ds_read_b64_tr_b16 v[104:105], v114 offset:12288
v_mfma_f32_16x16x32_bf16 v[20:23], v[84:87], v[68:71], v[20:23]
ds_read_b64_tr_b16 v[106:107], v114 offset:14336
v_mfma_f32_16x16x32_bf16 v[24:27], v[88:91], v[68:71], v[24:27]
ds_read_b64_tr_b16 v[108:109], v115 offset:12288
v_mfma_f32_16x16x32_bf16 v[28:31], v[92:95], v[68:71], v[28:31]
ds_read_b64_tr_b16 v[110:111], v115 offset:14336
s_waitcnt vmcnt(8)
s_waitcnt lgkmcnt(0)
v_mfma_f32_16x16x32_bf16 v[0:3], v[96:99], v[72:75], v[0:3]
ds_read_b64_tr_b16 v[80:81], v112 offset:16384
v_mfma_f32_16x16x32_bf16 v[4:7], v[100:103], v[72:75], v[4:7]
ds_read_b64_tr_b16 v[82:83], v112 offset:18432
s_add_u32 s64, s67, 28
s_and_b32 s64, s64, 31
s_lshl_b32 s65, s64, 10
buffer_load_dwordx4 v[64:67], v116, s[20:23], s65 offen sc1
v_mfma_f32_16x16x32_bf16 v[8:11], v[104:107], v[72:75], v[8:11]
ds_read_b64_tr_b16 v[84:85], v113 offset:16384
s_add_u32 s65, s65, 131072
buffer_load_dwordx4 v[68:71], v116, s[20:23], s65 offen sc1
v_mfma_f32_16x16x32_bf16 v[12:15], v[108:111], v[72:75], v[12:15]
ds_read_b64_tr_b16 v[86:87], v113 offset:18432
v_mfma_f32_16x16x32_bf16 v[16:19], v[96:99], v[76:79], v[16:19]
ds_read_b64_tr_b16 v[88:89], v114 offset:16384
v_mfma_f32_16x16x32_bf16 v[20:23], v[100:103], v[76:79], v[20:23]
ds_read_b64_tr_b16 v[90:91], v114 offset:18432
v_mfma_f32_16x16x32_bf16 v[24:27], v[104:107], v[76:79], v[24:27]
ds_read_b64_tr_b16 v[92:93], v115 offset:16384
v_mfma_f32_16x16x32_bf16 v[28:31], v[108:111], v[76:79], v[28:31]
ds_read_b64_tr_b16 v[94:95], v115 offset:18432
s_waitcnt vmcnt(8)
s_waitcnt lgkmcnt(0)
v_mfma_f32_16x16x32_bf16 v[0:3], v[80:83], v[32:35], v[0:3]
ds_read_b64_tr_b16 v[96:97], v112 offset:20480
v_mfma_f32_16x16x32_bf16 v[4:7], v[84:87], v[32:35], v[4:7]
ds_read_b64_tr_b16 v[98:99], v112 offset:22528
s_add_u32 s64, s67, 29
s_and_b32 s64, s64, 31
s_lshl_b32 s65, s64, 10
buffer_load_dwordx4 v[72:75], v116, s[20:23], s65 offen sc1
v_mfma_f32_16x16x32_bf16 v[8:11], v[88:91], v[32:35], v[8:11]
ds_read_b64_tr_b16 v[100:101], v113 offset:20480
s_add_u32 s65, s65, 131072
buffer_load_dwordx4 v[76:79], v116, s[20:23], s65 offen sc1
v_mfma_f32_16x16x32_bf16 v[12:15], v[92:95], v[32:35], v[12:15]
ds_read_b64_tr_b16 v[102:103], v113 offset:22528
v_mfma_f32_16x16x32_bf16 v[16:19], v[80:83], v[36:39], v[16:19]
ds_read_b64_tr_b16 v[104:105], v114 offset:20480
v_mfma_f32_16x16x32_bf16 v[20:23], v[84:87], v[36:39], v[20:23]
ds_read_b64_tr_b16 v[106:107], v114 offset:22528
v_mfma_f32_16x16x32_bf16 v[24:27], v[88:91], v[36:39], v[24:27]
ds_read_b64_tr_b16 v[108:109], v115 offset:20480
v_mfma_f32_16x16x32_bf16 v[28:31], v[92:95], v[36:39], v[28:31]
ds_read_b64_tr_b16 v[110:111], v115 offset:22528
s_waitcnt vmcnt(8)
s_waitcnt lgkmcnt(0)
v_mfma_f32_16x16x32_bf16 v[0:3], v[96:99], v[40:43], v[0:3]
ds_read_b64_tr_b16 v[80:81], v112 offset:24576
v_mfma_f32_16x16x32_bf16 v[4:7], v[100:103], v[40:43], v[4:7]
ds_read_b64_tr_b16 v[82:83], v112 offset:26624
s_add_u32 s64, s67, 30
s_and_b32 s64, s64, 31
s_lshl_b32 s65, s64, 10
buffer_load_dwordx4 v[32:35], v116, s[20:23], s65 offen sc1
v_mfma_f32_16x16x32_bf16 v[8:11], v[104:107], v[40:43], v[8:11]
ds_read_b64_tr_b16 v[84:85], v113 offset:24576
s_add_u32 s65, s65, 131072
buffer_load_dwordx4 v[36:39], v116, s[20:23], s65 offen sc1
v_mfma_f32_16x16x32_bf16 v[12:15], v[108:111], v[40:43], v[12:15]
ds_read_b64_tr_b16 v[86:87], v113 offset:26624
v_mfma_f32_16x16x32_bf16 v[16:19], v[96:99], v[44:47], v[16:19]
ds_read_b64_tr_b16 v[88:89], v114 offset:24576
v_mfma_f32_16x16x32_bf16 v[20:23], v[100:103], v[44:47], v[20:23]
ds_read_b64_tr_b16 v[90:91], v114 offset:26624
v_mfma_f32_16x16x32_bf16 v[24:27], v[104:107], v[44:47], v[24:27]
ds_read_b64_tr_b16 v[92:93], v115 offset:24576
v_mfma_f32_16x16x32_bf16 v[28:31], v[108:111], v[44:47], v[28:31]
ds_read_b64_tr_b16 v[94:95], v115 offset:26624
s_waitcnt vmcnt(8)
s_waitcnt lgkmcnt(0)
v_mfma_f32_16x16x32_bf16 v[0:3], v[80:83], v[48:51], v[0:3]
ds_read_b64_tr_b16 v[96:97], v112 offset:28672
v_mfma_f32_16x16x32_bf16 v[4:7], v[84:87], v[48:51], v[4:7]
ds_read_b64_tr_b16 v[98:99], v112 offset:30720
s_add_u32 s64, s67, 31
s_and_b32 s64, s64, 31
s_lshl_b32 s65, s64, 10
buffer_load_dwordx4 v[40:43], v116, s[20:23], s65 offen sc1
v_mfma_f32_16x16x32_bf16 v[8:11], v[88:91], v[48:51], v[8:11]
ds_read_b64_tr_b16 v[100:101], v113 offset:28672
s_add_u32 s65, s65, 131072
buffer_load_dwordx4 v[44:47], v116, s[20:23], s65 offen sc1
v_mfma_f32_16x16x32_bf16 v[12:15], v[92:95], v[48:51], v[12:15]
ds_read_b64_tr_b16 v[102:103], v113 offset:30720
v_mfma_f32_16x16x32_bf16 v[16:19], v[80:83], v[52:55], v[16:19]
ds_read_b64_tr_b16 v[104:105], v114 offset:28672
v_mfma_f32_16x16x32_bf16 v[20:23], v[84:87], v[52:55], v[20:23]
ds_read_b64_tr_b16 v[106:107], v114 offset:30720
v_mfma_f32_16x16x32_bf16 v[24:27], v[88:91], v[52:55], v[24:27]
ds_read_b64_tr_b16 v[108:109], v115 offset:28672
v_mfma_f32_16x16x32_bf16 v[28:31], v[92:95], v[52:55], v[28:31]
ds_read_b64_tr_b16 v[110:111], v115 offset:30720
s_waitcnt vmcnt(8)
s_waitcnt lgkmcnt(0)
v_mfma_f32_16x16x32_bf16 v[0:3], v[96:99], v[56:59], v[0:3]
ds_read_b64_tr_b16 v[80:81], v112 offset:32768
v_mfma_f32_16x16x32_bf16 v[4:7], v[100:103], v[56:59], v[4:7]
ds_read_b64_tr_b16 v[82:83], v112 offset:34816
v_mfma_f32_16x16x32_bf16 v[8:11], v[104:107], v[56:59], v[8:11]
ds_read_b64_tr_b16 v[84:85], v113 offset:32768
v_mfma_f32_16x16x32_bf16 v[12:15], v[108:111], v[56:59], v[12:15]
ds_read_b64_tr_b16 v[86:87], v113 offset:34816
v_mfma_f32_16x16x32_bf16 v[16:19], v[96:99], v[60:63], v[16:19]
ds_read_b64_tr_b16 v[88:89], v114 offset:32768
v_mfma_f32_16x16x32_bf16 v[20:23], v[100:103], v[60:63], v[20:23]
ds_read_b64_tr_b16 v[90:91], v114 offset:34816
v_mfma_f32_16x16x32_bf16 v[24:27], v[104:107], v[60:63], v[24:27]
ds_read_b64_tr_b16 v[92:93], v115 offset:32768
v_mfma_f32_16x16x32_bf16 v[28:31], v[108:111], v[60:63], v[28:31]
ds_read_b64_tr_b16 v[94:95], v115 offset:34816
s_waitcnt vmcnt(6)
s_waitcnt lgkmcnt(0)
v_mfma_f32_16x16x32_bf16 v[0:3], v[80:83], v[64:67], v[0:3]
ds_read_b64_tr_b16 v[96:97], v112 offset:36864
v_mfma_f32_16x16x32_bf16 v[4:7], v[84:87], v[64:67], v[4:7]
ds_read_b64_tr_b16 v[98:99], v112 offset:38912
v_mfma_f32_16x16x32_bf16 v[8:11], v[88:91], v[64:67], v[8:11]
ds_read_b64_tr_b16 v[100:101], v113 offset:36864
v_mfma_f32_16x16x32_bf16 v[12:15], v[92:95], v[64:67], v[12:15]
ds_read_b64_tr_b16 v[102:103], v113 offset:38912
v_mfma_f32_16x16x32_bf16 v[16:19], v[80:83], v[68:71], v[16:19]
ds_read_b64_tr_b16 v[104:105], v114 offset:36864
v_mfma_f32_16x16x32_bf16 v[20:23], v[84:87], v[68:71], v[20:23]
ds_read_b64_tr_b16 v[106:107], v114 offset:38912
v_mfma_f32_16x16x32_bf16 v[24:27], v[88:91], v[68:71], v[24:27]
ds_read_b64_tr_b16 v[108:109], v115 offset:36864
v_mfma_f32_16x16x32_bf16 v[28:31], v[92:95], v[68:71], v[28:31]
ds_read_b64_tr_b16 v[110:111], v115 offset:38912
s_waitcnt vmcnt(4)
s_waitcnt lgkmcnt(0)
v_mfma_f32_16x16x32_bf16 v[0:3], v[96:99], v[72:75], v[0:3]
ds_read_b64_tr_b16 v[80:81], v112 offset:0
v_mfma_f32_16x16x32_bf16 v[4:7], v[100:103], v[72:75], v[4:7]
ds_read_b64_tr_b16 v[82:83], v112 offset:2048
v_mfma_f32_16x16x32_bf16 v[8:11], v[104:107], v[72:75], v[8:11]
ds_read_b64_tr_b16 v[84:85], v113 offset:0
v_mfma_f32_16x16x32_bf16 v[12:15], v[108:111], v[72:75], v[12:15]
ds_read_b64_tr_b16 v[86:87], v113 offset:2048
v_mfma_f32_16x16x32_bf16 v[16:19], v[96:99], v[76:79], v[16:19]
ds_read_b64_tr_b16 v[88:89], v114 offset:0
v_mfma_f32_16x16x32_bf16 v[20:23], v[100:103], v[76:79], v[20:23]
ds_read_b64_tr_b16 v[90:91], v114 offset:2048
v_mfma_f32_16x16x32_bf16 v[24:27], v[104:107], v[76:79], v[24:27]
ds_read_b64_tr_b16 v[92:93], v115 offset:0
v_mfma_f32_16x16x32_bf16 v[28:31], v[108:111], v[76:79], v[28:31]
ds_read_b64_tr_b16 v[94:95], v115 offset:2048
s_waitcnt vmcnt(2)
s_waitcnt lgkmcnt(0)
v_mfma_f32_16x16x32_bf16 v[0:3], v[80:83], v[32:35], v[0:3]
ds_read_b64_tr_b16 v[96:97], v112 offset:4096
v_mfma_f32_16x16x32_bf16 v[4:7], v[84:87], v[32:35], v[4:7]
ds_read_b64_tr_b16 v[98:99], v112 offset:6144
v_mfma_f32_16x16x32_bf16 v[8:11], v[88:91], v[32:35], v[8:11]
ds_read_b64_tr_b16 v[100:101], v113 offset:4096
v_mfma_f32_16x16x32_bf16 v[12:15], v[92:95], v[32:35], v[12:15]
ds_read_b64_tr_b16 v[102:103], v113 offset:6144
v_mfma_f32_16x16x32_bf16 v[16:19], v[80:83], v[36:39], v[16:19]
ds_read_b64_tr_b16 v[104:105], v114 offset:4096
v_mfma_f32_16x16x32_bf16 v[20:23], v[84:87], v[36:39], v[20:23]
ds_read_b64_tr_b16 v[106:107], v114 offset:6144
v_mfma_f32_16x16x32_bf16 v[24:27], v[88:91], v[36:39], v[24:27]
ds_read_b64_tr_b16 v[108:109], v115 offset:4096
v_mfma_f32_16x16x32_bf16 v[28:31], v[92:95], v[36:39], v[28:31]
ds_read_b64_tr_b16 v[110:111], v115 offset:6144
s_waitcnt vmcnt(0)
s_waitcnt lgkmcnt(0)
v_mfma_f32_16x16x32_bf16 v[0:3], v[96:99], v[40:43], v[0:3]
v_mfma_f32_16x16x32_bf16 v[4:7], v[100:103], v[40:43], v[4:7]
v_mfma_f32_16x16x32_bf16 v[8:11], v[104:107], v[40:43], v[8:11]
v_mfma_f32_16x16x32_bf16 v[12:15], v[108:111], v[40:43], v[12:15]
v_mfma_f32_16x16x32_bf16 v[16:19], v[96:99], v[44:47], v[16:19]
v_mfma_f32_16x16x32_bf16 v[20:23], v[100:103], v[44:47], v[20:23]
v_mfma_f32_16x16x32_bf16 v[24:27], v[104:107], v[44:47], v[24:27]
v_mfma_f32_16x16x32_bf16 v[28:31], v[108:111], v[44:47], v[28:31]
s_nop 7
ds_write_b128 v253, v[0:3] offset:0
ds_write_b128 v253, v[4:7] offset:1024
ds_write_b128 v253, v[8:11] offset:2048
ds_write_b128 v253, v[12:15] offset:3072
ds_write_b128 v253, v[16:19] offset:4096
ds_write_b128 v253, v[20:23] offset:5120
ds_write_b128 v253, v[24:27] offset:6144
ds_write_b128 v253, v[28:31] offset:7168
s_lshl_b32 s47, s44, 6
v_add_u32 v71, s47, v221
v_and_b32 v66, 15, v71
v_lshrrev_b32 v67, 4, v71
v_lshrrev_b32 v68, 2, v66
v_lshlrev_b32 v68, 10, v68
v_and_b32 v69, 3, v66
v_lshlrev_b32 v69, 4, v69
v_add_u32 v69, v69, v67
v_lshlrev_b32 v69, 4, v69
v_add_u32 v68, v68, v69
v_add_u32 v72, 81920, v68
s_lshl_b32 s47, s62, 5
v_add_u32 v70, s47, v67
v_mul_u32_u24 v70, 1152, v70
v_lshlrev_b32 v66, 3, v66
v_add_u32 v70, v70, v66
s_lshl_b32 s47, s63, 7
v_add_u32 v70, s47, v70
s_mov_b32 s28, s14
s_and_b32 s29, s15, 0xffff
s_mov_b32 s30, 1032192
s_mov_b32 s31, 0x20000
s_mov_b32 s48, 18432
s_waitcnt lgkmcnt(0)
s_barrier
ds_read_b128 v[0:3], v68 offset:0
ds_read_b128 v[4:7], v68 offset:40960
ds_read_b128 v[8:11], v72 offset:0
ds_read_b128 v[12:15], v72 offset:40960
ds_read_b128 v[16:19], v68 offset:4096
ds_read_b128 v[20:23], v68 offset:45056
ds_read_b128 v[24:27], v72 offset:4096
ds_read_b128 v[28:31], v72 offset:45056
s_waitcnt lgkmcnt(4)
v_pk_add_f32 v[0:1], v[0:1], v[4:5]
v_pk_add_f32 v[8:9], v[8:9], v[12:13]
v_pk_add_f32 v[2:3], v[2:3], v[6:7]
v_pk_add_f32 v[10:11], v[10:11], v[14:15]
v_pk_add_f32 v[0:1], v[0:1], v[8:9]
v_pk_add_f32 v[2:3], v[2:3], v[10:11]
v_cvt_pk_bf16_f32 v40, v0, v1
v_cvt_pk_bf16_f32 v41, v2, v3
buffer_store_dwordx2 v[40:41], v70, s[28:31], 0 offen
s_waitcnt lgkmcnt(0)
v_pk_add_f32 v[16:17], v[16:17], v[20:21]
v_pk_add_f32 v[24:25], v[24:25], v[28:29]
v_pk_add_f32 v[18:19], v[18:19], v[22:23]
v_pk_add_f32 v[26:27], v[26:27], v[30:31]
v_pk_add_f32 v[16:17], v[16:17], v[24:25]
v_pk_add_f32 v[18:19], v[18:19], v[26:27]
v_cvt_pk_bf16_f32 v42, v16, v17
v_cvt_pk_bf16_f32 v43, v18, v19
buffer_store_dwordx2 v[42:43], v70, s[28:31], s48 offen
s_branch L_attn_end
L_fallback:
s_waitcnt vmcnt(0) lgkmcnt(0)
s_barrier
s_mov_b32 s60, 1
s_branch L_restart
L_qread_tm:
ds_read_b128 v[0:3], v244 offset:0
ds_read_b128 v[4:7], v244 offset:40960
ds_read_b128 v[8:11], v245 offset:0
ds_read_b128 v[12:15], v245 offset:40960
ds_read_b128 v[16:19], v244 offset:1024
ds_read_b128 v[20:23], v244 offset:41984
ds_read_b128 v[24:27], v245 offset:1024
ds_read_b128 v[28:31], v245 offset:41984
ds_read_b128 v[32:35], v244 offset:2048
ds_read_b128 v[36:39], v244 offset:43008
ds_read_b128 v[40:43], v245 offset:2048
ds_read_b128 v[44:47], v245 offset:43008
ds_read_b128 v[48:51], v244 offset:3072
ds_read_b128 v[52:55], v244 offset:44032
ds_read_b128 v[56:59], v245 offset:3072
ds_read_b128 v[60:63], v245 offset:44032
ds_read_b128 v[64:67], v244 offset:4096
ds_read_b128 v[68:71], v244 offset:45056
ds_read_b128 v[72:75], v245 offset:4096
ds_read_b128 v[76:79], v245 offset:45056
ds_read_b128 a[224:227], v244 offset:5120
ds_read_b128 a[228:231], v244 offset:46080
ds_read_b128 a[232:235], v245 offset:5120
ds_read_b128 a[236:239], v245 offset:46080
ds_read_b128 a[240:243], v244 offset:6144
ds_read_b128 a[244:247], v244 offset:47104
ds_read_b128 a[248:251], v245 offset:6144
ds_read_b128 a[252:255], v245 offset:47104
s_add_u32 m0, s51, 24576
s_add_u32 s58, s56, 32768
s_sub_u32 s58, s58, s57
buffer_load_dwordx4 v212, s[32:35], s58 offen nt lds
buffer_load_dwordx4 v213, s[32:35], s58 offen offset:1024 nt lds
buffer_load_dwordx4 v212, s[32:35], s58 offen offset:2048 nt lds
buffer_load_dwordx4 v213, s[32:35], s58 offen offset:3072 nt lds
s_add_u32 m0, s51, 28672
s_add_u32 s58, s58, 4096
buffer_load_dwordx4 v212, s[32:35], s58 offen nt lds
buffer_load_dwordx4 v213, s[32:35], s58 offen offset:1024 nt lds
buffer_load_dwordx4 v212, s[32:35], s58 offen offset:2048 nt lds
buffer_load_dwordx4 v213, s[32:35], s58 offen offset:3072 nt lds
L_truemax:
v_mov_b32 v224, 0xff800000
v_mov_b32 v225, 0xff800000
v_mov_b32 v226, 0xff800000
v_mov_b32 v227, 0xff800000
v_mov_b32 v228, 0xff800000
v_mov_b32 v229, 0xff800000
v_mov_b32 v230, 0xff800000
s_mov_b32 s49, 0
L_tm_loop:
s_lshr_b32 s47, s57, 15
s_xor_b32 s47, s47, s49
s_lshl_b32 s47, s47, 15
s_add_u32 s58, s56, s47
s_waitcnt vmcnt(0) lgkmcnt(0)
s_add_u32 m0, s51, 0
s_nop 0
buffer_load_dwordx4 v208, s[28:31], s58 offen offset:0 lds
buffer_load_dwordx4 v209, s[28:31], s58 offen offset:1024 lds
buffer_load_dwordx4 v210, s[28:31], s58 offen offset:2048 lds
buffer_load_dwordx4 v211, s[28:31], s58 offen offset:3072 lds
s_add_u32 m0, s51, 4096
s_add_u32 s58, s58, 4096
buffer_load_dwordx4 v208, s[28:31], s58 offen offset:0 lds
buffer_load_dwordx4 v209, s[28:31], s58 offen offset:1024 lds
buffer_load_dwordx4 v210, s[28:31], s58 offen offset:2048 lds
buffer_load_dwordx4 v211, s[28:31], s58 offen offset:3072 lds
s_waitcnt vmcnt(0)
ds_read_b128 v[108:111], v196 offset:0
ds_read_b128 v[112:115], v197 offset:0
ds_read_b128 v[116:119], v198 offset:0
ds_read_b128 v[120:123], v199 offset:0
ds_read_b128 v[124:127], v196 offset:4096
ds_read_b128 v[128:131], v197 offset:4096
ds_read_b128 v[132:135], v198 offset:4096
ds_read_b128 v[136:139], v199 offset:4096
s_waitcnt lgkmcnt(0)
v_mfma_f32_16x16x32_bf16 v[172:175], v[108:111], v[0:3], 0
v_mfma_f32_16x16x32_bf16 v[172:175], v[112:115], v[4:7], v[172:175]
v_mfma_f32_16x16x32_bf16 v[172:175], v[116:119], v[8:11], v[172:175]
v_mfma_f32_16x16x32_bf16 v[172:175], v[120:123], v[12:15], v[172:175]
v_mfma_f32_16x16x32_bf16 v[176:179], v[124:127], v[0:3], 0
v_mfma_f32_16x16x32_bf16 v[176:179], v[128:131], v[4:7], v[176:179]
v_mfma_f32_16x16x32_bf16 v[176:179], v[132:135], v[8:11], v[176:179]
v_mfma_f32_16x16x32_bf16 v[176:179], v[136:139], v[12:15], v[176:179]
s_nop 7
v_max3_f32 v224, v224, v172, v173
v_max3_f32 v224, v224, v174, v175
v_max3_f32 v224, v224, v176, v177
v_max3_f32 v224, v224, v178, v179
s_nop 3
v_mfma_f32_16x16x32_bf16 v[172:175], v[108:111], v[16:19], 0
v_mfma_f32_16x16x32_bf16 v[172:175], v[112:115], v[20:23], v[172:175]
v_mfma_f32_16x16x32_bf16 v[172:175], v[116:119], v[24:27], v[172:175]
v_mfma_f32_16x16x32_bf16 v[172:175], v[120:123], v[28:31], v[172:175]
v_mfma_f32_16x16x32_bf16 v[176:179], v[124:127], v[16:19], 0
v_mfma_f32_16x16x32_bf16 v[176:179], v[128:131], v[20:23], v[176:179]
v_mfma_f32_16x16x32_bf16 v[176:179], v[132:135], v[24:27], v[176:179]
v_mfma_f32_16x16x32_bf16 v[176:179], v[136:139], v[28:31], v[176:179]
s_nop 7
v_max3_f32 v225, v225, v172, v173
v_max3_f32 v225, v225, v174, v175
v_max3_f32 v225, v225, v176, v177
v_max3_f32 v225, v225, v178, v179
s_nop 3
v_mfma_f32_16x16x32_bf16 v[172:175], v[108:111], v[32:35], 0
v_mfma_f32_16x16x32_bf16 v[172:175], v[112:115], v[36:39], v[172:175]
v_mfma_f32_16x16x32_bf16 v[172:175], v[116:119], v[40:43], v[172:175]
v_mfma_f32_16x16x32_bf16 v[172:175], v[120:123], v[44:47], v[172:175]
v_mfma_f32_16x16x32_bf16 v[176:179], v[124:127], v[32:35], 0
v_mfma_f32_16x16x32_bf16 v[176:179], v[128:131], v[36:39], v[176:179]
v_mfma_f32_16x16x32_bf16 v[176:179], v[132:135], v[40:43], v[176:179]
v_mfma_f32_16x16x32_bf16 v[176:179], v[136:139], v[44:47], v[176:179]
s_nop 7
v_max3_f32 v226, v226, v172, v173
v_max3_f32 v226, v226, v174, v175
v_max3_f32 v226, v226, v176, v177
v_max3_f32 v226, v226, v178, v179
s_nop 3
v_mfma_f32_16x16x32_bf16 v[172:175], v[108:111], v[48:51], 0
v_mfma_f32_16x16x32_bf16 v[172:175], v[112:115], v[52:55], v[172:175]
v_mfma_f32_16x16x32_bf16 v[172:175], v[116:119], v[56:59], v[172:175]
v_mfma_f32_16x16x32_bf16 v[172:175], v[120:123], v[60:63], v[172:175]
v_mfma_f32_16x16x32_bf16 v[176:179], v[124:127], v[48:51], 0
v_mfma_f32_16x16x32_bf16 v[176:179], v[128:131], v[52:55], v[176:179]
v_mfma_f32_16x16x32_bf16 v[176:179], v[132:135], v[56:59], v[176:179]
v_mfma_f32_16x16x32_bf16 v[176:179], v[136:139], v[60:63], v[176:179]
s_nop 7
v_max3_f32 v227, v227, v172, v173
v_max3_f32 v227, v227, v174, v175
v_max3_f32 v227, v227, v176, v177
v_max3_f32 v227, v227, v178, v179
s_nop 3
v_mfma_f32_16x16x32_bf16 v[172:175], v[108:111], v[64:67], 0
v_mfma_f32_16x16x32_bf16 v[172:175], v[112:115], v[68:71], v[172:175]
v_mfma_f32_16x16x32_bf16 v[172:175], v[116:119], v[72:75], v[172:175]
v_mfma_f32_16x16x32_bf16 v[172:175], v[120:123], v[76:79], v[172:175]
v_mfma_f32_16x16x32_bf16 v[176:179], v[124:127], v[64:67], 0
v_mfma_f32_16x16x32_bf16 v[176:179], v[128:131], v[68:71], v[176:179]
v_mfma_f32_16x16x32_bf16 v[176:179], v[132:135], v[72:75], v[176:179]
v_mfma_f32_16x16x32_bf16 v[176:179], v[136:139], v[76:79], v[176:179]
s_nop 7
v_max3_f32 v228, v228, v172, v173
v_max3_f32 v228, v228, v174, v175
v_max3_f32 v228, v228, v176, v177
v_max3_f32 v228, v228, v178, v179
s_nop 3
v_mfma_f32_16x16x32_bf16 v[172:175], v[108:111], a[224:227], 0
v_mfma_f32_16x16x32_bf16 v[172:175], v[112:115], a[228:231], v[172:175]
v_mfma_f32_16x16x32_bf16 v[172:175], v[116:119], a[232:235], v[172:175]
v_mfma_f32_16x16x32_bf16 v[172:175], v[120:123], a[236:239], v[172:175]
v_mfma_f32_16x16x32_bf16 v[176:179], v[124:127], a[224:227], 0
v_mfma_f32_16x16x32_bf16 v[176:179], v[128:131], a[228:231], v[176:179]
v_mfma_f32_16x16x32_bf16 v[176:179], v[132:135], a[232:235], v[176:179]
v_mfma_f32_16x16x32_bf16 v[176:179], v[136:139], a[236:239], v[176:179]
s_nop 7
v_max3_f32 v229, v229, v172, v173
v_max3_f32 v229, v229, v174, v175
v_max3_f32 v229, v229, v176, v177
v_max3_f32 v229, v229, v178, v179
s_nop 3
v_mfma_f32_16x16x32_bf16 v[172:175], v[108:111], a[240:243], 0
v_mfma_f32_16x16x32_bf16 v[172:175], v[112:115], a[244:247], v[172:175]
v_mfma_f32_16x16x32_bf16 v[172:175], v[116:119], a[248:251], v[172:175]
v_mfma_f32_16x16x32_bf16 v[172:175], v[120:123], a[252:255], v[172:175]
v_mfma_f32_16x16x32_bf16 v[176:179], v[124:127], a[240:243], 0
v_mfma_f32_16x16x32_bf16 v[176:179], v[128:131], a[244:247], v[176:179]
v_mfma_f32_16x16x32_bf16 v[176:179], v[132:135], a[248:251], v[176:179]
v_mfma_f32_16x16x32_bf16 v[176:179], v[136:139], a[252:255], v[176:179]
s_nop 7
v_max3_f32 v230, v230, v172, v173
v_max3_f32 v230, v230, v174, v175
v_max3_f32 v230, v230, v176, v177
v_max3_f32 v230, v230, v178, v179
s_nop 3
s_add_u32 s49, s49, 1
s_cmp_lt_u32 s49, 8
s_cbranch_scc1 L_tm_loop
v_mov_b32 v232, v224
v_mov_b32 v233, v225
v_mov_b32 v234, v226
v_mov_b32 v235, v227
v_mov_b32 v236, v228
v_mov_b32 v237, v229
v_mov_b32 v238, v230
s_nop 1
v_permlane32_swap_b32 v224, v232
v_permlane32_swap_b32 v225, v233
v_permlane32_swap_b32 v226, v234
v_permlane32_swap_b32 v227, v235
v_permlane32_swap_b32 v228, v236
v_permlane32_swap_b32 v229, v237
v_permlane32_swap_b32 v230, v238
s_nop 1
v_max_f32 v224, v224, v232
v_max_f32 v225, v225, v233
v_max_f32 v226, v226, v234
v_max_f32 v227, v227, v235
v_max_f32 v228, v228, v236
v_max_f32 v229, v229, v237
v_max_f32 v230, v230, v238
v_mov_b32 v232, v224
v_mov_b32 v233, v225
v_mov_b32 v234, v226
v_mov_b32 v235, v227
v_mov_b32 v236, v228
v_mov_b32 v237, v229
v_mov_b32 v238, v230
s_nop 1
v_permlane16_swap_b32 v224, v232
v_permlane16_swap_b32 v225, v233
v_permlane16_swap_b32 v226, v234
v_permlane16_swap_b32 v227, v235
v_permlane16_swap_b32 v228, v236
v_permlane16_swap_b32 v229, v237
v_permlane16_swap_b32 v230, v238
s_nop 1
v_max_f32 v224, v224, v232
v_max_f32 v225, v225, v233
v_max_f32 v226, v226, v234
v_max_f32 v227, v227, v235
v_max_f32 v228, v228, v236
v_max_f32 v229, v229, v237
v_max_f32 v230, v230, v238
v_lshlrev_b32 v240, 4, v223
s_lshl_b32 s47, s44, 2
v_add_u32 v241, s47, v240
v_add_u32 v242, 40960, v241
v_add_u32 v243, 40960, v240
ds_write_b32 v241, v224 offset:39936
ds_write_b32 v241, v225 offset:40192
ds_write_b32 v241, v226 offset:40448
ds_write_b32 v241, v227 offset:40704
ds_write_b32 v242, v228 offset:39936
ds_write_b32 v242, v229 offset:40192
ds_write_b32 v242, v230 offset:40448
s_waitcnt lgkmcnt(0)
s_barrier
ds_read_b128 v[80:83], v240 offset:39936
ds_read_b128 v[84:87], v240 offset:40192
ds_read_b128 v[88:91], v240 offset:40448
ds_read_b128 v[92:95], v240 offset:40704
ds_read_b128 v[96:99], v243 offset:39936
ds_read_b128 v[100:103], v243 offset:40192
ds_read_b128 v[104:107], v243 offset:40448
s_waitcnt lgkmcnt(0)
v_max3_f32 v224, v80, v81, v82
v_max3_f32 v225, v84, v85, v86
v_max3_f32 v226, v88, v89, v90
v_max3_f32 v227, v92, v93, v94
v_max3_f32 v228, v96, v97, v98
v_max3_f32 v229, v100, v101, v102
v_max3_f32 v230, v104, v105, v106
v_max_f32 v224, v224, v83
v_max_f32 v225, v225, v87
v_max_f32 v226, v226, v91
v_max_f32 v227, v227, v95
v_max_f32 v228, v228, v99
v_max_f32 v229, v229, v103
v_max_f32 v230, v230, v107
v_sub_f32 v80, 0, v224
v_sub_f32 v81, 0, v224
v_sub_f32 v82, 0, v224
v_sub_f32 v83, 0, v224
v_sub_f32 v84, 0, v225
v_sub_f32 v85, 0, v225
v_sub_f32 v86, 0, v225
v_sub_f32 v87, 0, v225
v_sub_f32 v88, 0, v226
v_sub_f32 v89, 0, v226
v_sub_f32 v90, 0, v226
v_sub_f32 v91, 0, v226
v_sub_f32 v92, 0, v227
v_sub_f32 v93, 0, v227
v_sub_f32 v94, 0, v227
v_sub_f32 v95, 0, v227
v_sub_f32 v96, 0, v228
v_sub_f32 v97, 0, v228
v_sub_f32 v98, 0, v228
v_sub_f32 v99, 0, v228
v_sub_f32 v100, 0, v229
v_sub_f32 v101, 0, v229
v_sub_f32 v102, 0, v229
v_sub_f32 v103, 0, v229
v_sub_f32 v104, 0, v230
v_sub_f32 v105, 0, v230
v_sub_f32 v106, 0, v230
v_sub_f32 v107, 0, v230
s_add_u32 s58, s56, s57
s_add_u32 m0, s51, 0
s_nop 0
buffer_load_dwordx4 v208, s[28:31], s58 offen offset:0 lds
buffer_load_dwordx4 v209, s[28:31], s58 offen offset:1024 lds
buffer_load_dwordx4 v210, s[28:31], s58 offen offset:2048 lds
buffer_load_dwordx4 v211, s[28:31], s58 offen offset:3072 lds
s_add_u32 m0, s51, 4096
s_add_u32 s58, s58, 4096
buffer_load_dwordx4 v208, s[28:31], s58 offen offset:0 lds
buffer_load_dwordx4 v209, s[28:31], s58 offen offset:1024 lds
buffer_load_dwordx4 v210, s[28:31], s58 offen offset:2048 lds
buffer_load_dwordx4 v211, s[28:31], s58 offen offset:3072 lds
s_waitcnt vmcnt(0)
ds_read_b128 v[108:111], v196 offset:0
ds_read_b128 v[112:115], v197 offset:0
ds_read_b128 v[116:119], v198 offset:0
ds_read_b128 v[120:123], v199 offset:0
ds_read_b128 v[124:127], v196 offset:4096
ds_read_b128 v[128:131], v197 offset:4096
ds_read_b128 v[132:135], v198 offset:4096
ds_read_b128 v[136:139], v199 offset:4096
s_waitcnt lgkmcnt(0)
s_mul_i32 s47, s2, 24576
s_add_u32 s47, s47, 16777216
s_add_u32 s40, s18, s47
s_addc_u32 s41, s19, 0
s_and_b32 s41, s41, 0xffff
s_mov_b32 s42, 24576
s_mov_b32 s43, 0x20000
s_mul_i32 s71, s44, 6144
v_lshlrev_b32 v252, 4, v221
v_add_u32 v253, s51, v252
s_lshr_b32 s48, s2, 3
s_and_b32 s47, s2, 1
s_lshr_b32 s49, s2, 1
s_and_b32 s49, s49, 3
s_mul_i32 s49, s49, 7
s_lshr_b32 s62, s48, 2
s_and_b32 s50, s48, 3
s_mul_i32 s63, s47, 5
s_add_u32 s63, s63, s50
s_lshl_b32 s77, s47, 2
s_add_u32 s77, s77, s50
s_cmp_ge_u32 s48, 28
s_cselect_b32 s62, s77, s62
s_cselect_b32 s63, 4, s63
s_cselect_b32 s50, 2, s50
s_cmp_ge_u32 s62, 7
s_cselect_b32 s70, 252, 0
s_min_u32 s62, s62, 6
s_add_u32 s62, s62, s49
s_mul_i32 s67, s62, 0
s_mul_i32 s50, s50, 0
s_add_u32 s67, s67, s50
s_lshl_b32 s47, s63, 7
s_add_u32 s24, s12, s47
s_addc_u32 s25, s13, 0
s_and_b32 s25, s25, 0xffff
s_sub_u32 s26, 4718592, s47
s_mov_b32 s27, 0x20000
s_lshl_b32 s47, s62, 18
s_add_u32 s20, s18, s47
s_addc_u32 s21, s19, 0
s_and_b32 s21, s21, 0xffff
s_mov_b32 s22, 262144
s_mov_b32 s23, 0x20000
s_mul_i32 s47, s45, 7
s_lshl_b32 s47, s47, 17
s_lshl_b32 s48, s46, 12
s_add_u32 s47, s47, s48
s_lshl_b32 s48, s44, 10
s_add_u32 s47, s47, s48
s_add_u32 s36, s18, s47
s_addc_u32 s37, s19, 0
s_and_b32 s37, s37, 0xffff
s_mov_b32 s38, 787456
s_mov_b32 s39, 0x20000
s_mov_b32 s72, s12
s_and_b32 s73, s13, 0xffff
s_mov_b32 s74, 4718592
s_mov_b32 s75, 0x20000
s_branch L_main_entry
L_attn_end:
s_endpgm
L_code_end:
.section .rodata,"a"
.p2align 6
.amdhsa_kernel standalone__gqa_block_cached__near_ridge_kernel
  .amdhsa_next_free_vgpr 512
  .amdhsa_next_free_sgpr 102
  .amdhsa_accum_offset 256
  .amdhsa_group_segment_fixed_size 0
  .amdhsa_kernarg_size 64
  .amdhsa_user_sgpr_count 2
  .amdhsa_user_sgpr_kernarg_segment_ptr 1
  .amdhsa_system_sgpr_workgroup_id_x 1
  .amdhsa_float_denorm_mode_32 3
  .amdhsa_float_denorm_mode_16_64 3
.end_amdhsa_kernel
```
